```python
import torch

def _softmax(x, axis=-1):
    return torch.softmax(x, dim=axis)
def _gelu(x):
    return torch.nn.functional.gelu(x, approximate="tanh")
def _silu(x):
    return torch.nn.functional.silu(x)
def _sigmoid(x):
    return torch.sigmoid(x)
def _layernorm(x, axis=-1, eps=1e-5):
    m = x.mean(dim=axis, keepdim=True)
    v = x.var(dim=axis, keepdim=True, unbiased=False)
    return (x - m) / torch.sqrt(v + eps)
def _scatter_add(tgt, idx, src, axis=0):
    return tgt.clone().index_add_(axis, idx, src)
def _segment_sum(src, seg, n):
    out = torch.zeros((n,) + src.shape[1:], dtype=src.dtype)
    return out.index_add_(0, seg, src)
def _pad(x, pw):
    flat = tuple(v for pair in reversed(pw) for v in pair)
    return torch.nn.functional.pad(x, flat)

kernel_name = 'recurrent_scan__ssm_conv_s4d__dense_activation_relu__prompt'

def setup_inputs():

    _w = (lambda a: (lambda t: t.to(torch.bfloat16) if t.is_floating_point() else t)(torch.as_tensor(a)))
    def _A_setup():
        Bsz, L, D, N = 1, 2048, 448, 256
        return {
            "u": _w((lambda *s: torch.randn(*s, dtype=torch.bfloat16) * 0.05)(Bsz, L, D)),
            "log_A_real": _w((lambda *s: torch.randn(*s, dtype=torch.bfloat16) * 6.4)(D, N) * 0.5),
            "A_imag": _w((lambda *s: torch.randn(*s, dtype=torch.bfloat16) * 0.05)(D, N) * 3.14),
            "C_real": _w((lambda *s: torch.randn(*s, dtype=torch.bfloat16) * 0.05)(D, N) / N ** 0.5),
            "C_imag": _w((lambda *s: torch.randn(*s, dtype=torch.bfloat16) * 0.05)(D, N) / N ** 0.5),
            "log_dt": _w((lambda *s: torch.randn(*s, dtype=torch.bfloat16) * 0.05)(D) * 0.5 - 4.0),
            "D_skip": _w((lambda *s: torch.randn(*s, dtype=torch.bfloat16) * 0.05)(D)),
        }
    _A_in = _A_setup()

    def _B_setup():
        B, S, D, Dff = 1, 2048, 448, 1792
        return {
            "x": _w((lambda *s: torch.randn(*s, dtype=torch.bfloat16) * 0.05)(B, S, D)),
            "w1": _w((lambda *s: torch.randn(*s, dtype=torch.bfloat16) * 0.05)(D, Dff)),
            "w2": _w((lambda *s: torch.randn(*s, dtype=torch.bfloat16) * 0.05)(Dff, D)),
        }
    _B_in = _B_setup()

    return {
        "A_u": _A_in["u"],
        "A_log_A_real": _A_in["log_A_real"],
        "A_A_imag": _A_in["A_imag"],
        "A_C_real": _A_in["C_real"],
        "A_C_imag": _A_in["C_imag"],
        "A_log_dt": _A_in["log_dt"],
        "A_D_skip": _A_in["D_skip"],
        "B_x": _B_in["x"],
        "B_w1": _B_in["w1"],
        "B_w2": _B_in["w2"],
    }

def reference(A_u, A_log_A_real, A_A_imag, A_C_real, A_C_imag, A_log_dt, A_D_skip, B_x, B_w1, B_w2):
    def _A_ref(u, log_A_real, A_imag, C_real, C_imag, log_dt, D_skip):
        L = u.shape[1]
        dt = torch.exp(log_dt)
        A = -torch.exp(log_A_real) + 1j * A_imag
        C = (C_real + 1j * C_imag) * dt[:, None]
        pos = (lambda x, dt: x.to(dt))(torch.arange(L), log_dt.dtype)
        P = torch.exp((A * dt[:, None])[:, :, None] * pos[None, None, :])
        K = 2.0 * torch.einsum("dn,dnl->dl", C, P).real
        L2 = 2 * L
        u_t = (lambda x, *d: x.permute(*d))(u, 0, 2, 1)
        Kf = (lambda x, *a, **k: torch.fft.rfft(x.float(), *a, **k))(K, L2)
        Uf = (lambda x, *a, **k: torch.fft.rfft(x.float(), *a, **k))(u_t, L2)
        y = (lambda x, *a, **k: torch.fft.irfft(x, *a, **k).to(torch.bfloat16))(Uf * Kf[None, :, :], L2)[:, :, :L]
        y = (lambda x, *d: x.permute(*d))(y, 0, 2, 1)
        return y + u * D_skip[None, None, :]

    def _B_ref(x, w1, w2):
        h = torch.einsum("bsd,df->bsf", x, w1)
        zero = torch.zeros_like(h)
        h = torch.maximum(h, zero)
        return torch.einsum("bsf,fd->bsd", h, w2)

    x = A_u
    xn = _layernorm(x, axis=-1)
    s = _A_ref(xn, A_log_A_real, A_A_imag, A_C_real, A_C_imag, A_log_dt, A_D_skip)
    g = _silu(_B_ref(xn, B_w1, B_w2))
    return x + s * g
```

```asm
; @launch grid=(448,1,1) block=(256,1,1) lds=70144
.amdgcn_target "amdgcn-amd-amdhsa--gfx950"
.text
.globl recurrent_scan__ssm_conv_s4d__dense_activation_relu__prompt_kernel
.p2align 8
.type recurrent_scan__ssm_conv_s4d__dense_activation_relu__prompt_kernel,@function
recurrent_scan__ssm_conv_s4d__dense_activation_relu__prompt_kernel:
    s_cmp_ge_u32 s2, 448
    s_cbranch_scc1 X_exit
    s_mov_b32 s28, s2
    s_load_dwordx16 s[4:19], s[0:1], 0
    s_load_dwordx8 s[56:63], s[0:1], 64
    s_load_dwordx2 s[64:65], s[0:1], 96
    v_readfirstlane_b32 s69, v0
    s_lshr_b32 s69, s69, 6
    s_mov_b32 s68, 0
    s_waitcnt lgkmcnt(0)
    s_mov_b32 s66, s62
    s_mov_b32 s67, s63
    s_add_u32 s70, s64, 29360128
    s_addc_u32 s71, s65, 0
    s_or_b32 s72, s2, s69
    s_cmp_lg_u32 s72, 0
    s_cbranch_scc1 X_nononce
    s_memrealtime s[72:73]
    s_waitcnt lgkmcnt(0)
    s_or_b32 s68, s72, 1
    v_mov_b32 v253, 0
    v_mov_b32 v254, s68
    s_mov_b64 exec, 1
    global_store_dword v253, v254, s[66:67] sc1
    s_mov_b64 exec, -1
X_nononce:
    v_mov_b32 v253, 0
    global_load_dword v255, v253, s[66:67] sc1
    s_cmp_ge_u32 s2, 224
    s_cbranch_scc1 B_start
    s_setprio 3
    s_cmp_ge_u32 s2, 128
    s_cbranch_scc1 A_wtonly
    s_mov_b32 s14, s64
    s_mov_b32 s15, s65
    s_mov_b32 s3, s2
    v_lshrrev_b32 v1, 6, v0
    v_and_b32 v2, 63, v0
    s_lshl_b32 s6, s3, 4
    v_lshl_add_u32 v3, v1, 2, s6
    v_mul_u32_u24 v3, 896, v3
    v_lshl_add_u32 v3, v2, 4, v3
    s_mul_i32 s7, s3, 14336
    v_lshrrev_b32 v29, 2, v2
    v_lshlrev_b32 v29, 10, v29
    v_and_b32 v28, 3, v2
    v_lshl_add_u32 v29, v28, 8, v29
    v_lshl_add_u32 v29, v1, 6, v29
    s_mov_b32 s20, 0x3b124925
    s_mov_b32 s21, 0x43e00000
    s_mov_b32 s22, 0x3727c5ac
    v_mov_b32 v8, 0
    v_mov_b32 v9, 0
    v_mov_b32 v10, 0
    v_mov_b32 v11, 0
    v_mov_b32 v12, 0
    v_mov_b32 v13, 0
    v_mov_b32 v14, 0
    v_mov_b32 v15, 0
    v_mov_b32 v16, 0
    v_mov_b32 v17, 0
    v_mov_b32 v18, 0
    v_mov_b32 v19, 0
    v_mov_b32 v20, 0
    v_mov_b32 v21, 0
    v_mov_b32 v22, 0
    v_mov_b32 v23, 0
    s_mov_b64 s[16:17], exec
    s_mov_b32 s18, -1
    s_mov_b32 s19, 0x00ffffff
    s_waitcnt lgkmcnt(0)
    s_mov_b64 exec, s[18:19]
    global_load_dwordx4 v[8:11], v3, s[4:5] offset:0
    global_load_dwordx4 v[12:15], v3, s[4:5] offset:896
    global_load_dwordx4 v[16:19], v3, s[4:5] offset:1792
    global_load_dwordx4 v[20:23], v3, s[4:5] offset:2688
    s_mov_b64 exec, s[16:17]
    s_waitcnt vmcnt(0)
    v_lshlrev_b32 v32, 16, v8
    v_and_b32 v33, 0xffff0000, v8
    v_lshlrev_b32 v34, 16, v9
    v_and_b32 v35, 0xffff0000, v9
    v_lshlrev_b32 v36, 16, v10
    v_and_b32 v37, 0xffff0000, v10
    v_lshlrev_b32 v38, 16, v11
    v_and_b32 v39, 0xffff0000, v11
    v_lshlrev_b32 v40, 16, v12
    v_and_b32 v41, 0xffff0000, v12
    v_lshlrev_b32 v42, 16, v13
    v_and_b32 v43, 0xffff0000, v13
    v_lshlrev_b32 v44, 16, v14
    v_and_b32 v45, 0xffff0000, v14
    v_lshlrev_b32 v46, 16, v15
    v_and_b32 v47, 0xffff0000, v15
    v_lshlrev_b32 v48, 16, v16
    v_and_b32 v49, 0xffff0000, v16
    v_lshlrev_b32 v50, 16, v17
    v_and_b32 v51, 0xffff0000, v17
    v_lshlrev_b32 v52, 16, v18
    v_and_b32 v53, 0xffff0000, v18
    v_lshlrev_b32 v54, 16, v19
    v_and_b32 v55, 0xffff0000, v19
    v_lshlrev_b32 v56, 16, v20
    v_and_b32 v57, 0xffff0000, v20
    v_lshlrev_b32 v58, 16, v21
    v_and_b32 v59, 0xffff0000, v21
    v_lshlrev_b32 v60, 16, v22
    v_and_b32 v61, 0xffff0000, v22
    v_lshlrev_b32 v62, 16, v23
    v_and_b32 v63, 0xffff0000, v23
    v_add_f32 v8, v32, v33
    v_add_f32 v9, v40, v41
    v_add_f32 v10, v48, v49
    v_add_f32 v11, v56, v57
    v_add_f32 v12, v34, v35
    v_add_f32 v13, v42, v43
    v_add_f32 v14, v50, v51
    v_add_f32 v15, v58, v59
    v_add_f32 v16, v36, v37
    v_add_f32 v17, v44, v45
    v_add_f32 v18, v52, v53
    v_add_f32 v19, v60, v61
    v_add_f32 v20, v38, v39
    v_add_f32 v21, v46, v47
    v_add_f32 v22, v54, v55
    v_add_f32 v23, v62, v63
    v_add_f32 v8, v8, v12
    v_add_f32 v9, v9, v13
    v_add_f32 v10, v10, v14
    v_add_f32 v11, v11, v15
    v_add_f32 v16, v16, v20
    v_add_f32 v17, v17, v21
    v_add_f32 v18, v18, v22
    v_add_f32 v19, v19, v23
    v_add_f32 v8, v8, v16
    v_add_f32 v9, v9, v17
    v_add_f32 v10, v10, v18
    v_add_f32 v11, v11, v19
    v_add_f32_dpp v8, v8, v8 row_shr:1 row_mask:0xf bank_mask:0xf bound_ctrl:0
    v_add_f32_dpp v9, v9, v9 row_shr:1 row_mask:0xf bank_mask:0xf bound_ctrl:0
    v_add_f32_dpp v10, v10, v10 row_shr:1 row_mask:0xf bank_mask:0xf bound_ctrl:0
    v_add_f32_dpp v11, v11, v11 row_shr:1 row_mask:0xf bank_mask:0xf bound_ctrl:0
    v_add_f32_dpp v8, v8, v8 row_shr:2 row_mask:0xf bank_mask:0xf bound_ctrl:0
    v_add_f32_dpp v9, v9, v9 row_shr:2 row_mask:0xf bank_mask:0xf bound_ctrl:0
    v_add_f32_dpp v10, v10, v10 row_shr:2 row_mask:0xf bank_mask:0xf bound_ctrl:0
    v_add_f32_dpp v11, v11, v11 row_shr:2 row_mask:0xf bank_mask:0xf bound_ctrl:0
    v_add_f32_dpp v8, v8, v8 row_shr:4 row_mask:0xf bank_mask:0xf bound_ctrl:0
    v_add_f32_dpp v9, v9, v9 row_shr:4 row_mask:0xf bank_mask:0xf bound_ctrl:0
    v_add_f32_dpp v10, v10, v10 row_shr:4 row_mask:0xf bank_mask:0xf bound_ctrl:0
    v_add_f32_dpp v11, v11, v11 row_shr:4 row_mask:0xf bank_mask:0xf bound_ctrl:0
    v_add_f32_dpp v8, v8, v8 row_shr:8 row_mask:0xf bank_mask:0xf bound_ctrl:0
    v_add_f32_dpp v9, v9, v9 row_shr:8 row_mask:0xf bank_mask:0xf bound_ctrl:0
    v_add_f32_dpp v10, v10, v10 row_shr:8 row_mask:0xf bank_mask:0xf bound_ctrl:0
    v_add_f32_dpp v11, v11, v11 row_shr:8 row_mask:0xf bank_mask:0xf bound_ctrl:0
    v_add_f32_dpp v8, v8, v8 row_bcast:15 row_mask:0xa bank_mask:0xf
    v_add_f32_dpp v9, v9, v9 row_bcast:15 row_mask:0xa bank_mask:0xf
    v_add_f32_dpp v10, v10, v10 row_bcast:15 row_mask:0xa bank_mask:0xf
    v_add_f32_dpp v11, v11, v11 row_bcast:15 row_mask:0xa bank_mask:0xf
    v_add_f32_dpp v8, v8, v8 row_bcast:31 row_mask:0xc bank_mask:0xf
    v_add_f32_dpp v9, v9, v9 row_bcast:31 row_mask:0xc bank_mask:0xf
    v_add_f32_dpp v10, v10, v10 row_bcast:31 row_mask:0xc bank_mask:0xf
    v_add_f32_dpp v11, v11, v11 row_bcast:31 row_mask:0xc bank_mask:0xf
    v_readlane_b32 s24, v8, 63
    v_readlane_b32 s25, v9, 63
    v_readlane_b32 s26, v10, 63
    v_readlane_b32 s27, v11, 63
    v_mov_b32 v12, s24
    v_mov_b32 v13, s25
    v_mov_b32 v14, s26
    v_mov_b32 v15, s27
    v_mul_f32 v16, s20, v12
    v_mul_f32 v17, s20, v13
    v_mul_f32 v18, s20, v14
    v_mul_f32 v19, s20, v15
    v_fma_f32 v20, -v16, s21, v12
    v_fma_f32 v21, -v17, s21, v13
    v_fma_f32 v22, -v18, s21, v14
    v_fma_f32 v23, -v19, s21, v15
    v_fma_f32 v16, v20, s20, v16
    v_fma_f32 v17, v21, s20, v17
    v_fma_f32 v18, v22, s20, v18
    v_fma_f32 v19, v23, s20, v19
    v_mov_b32 v8, 0
    v_mov_b32 v9, 0
    v_mov_b32 v10, 0
    v_mov_b32 v11, 0
    s_mov_b64 exec, s[18:19]
    v_sub_f32 v12, v32, v16
    v_sub_f32 v13, v40, v17
    v_sub_f32 v14, v48, v18
    v_sub_f32 v15, v56, v19
    v_fmac_f32 v8, v12, v12
    v_fmac_f32 v9, v13, v13
    v_fmac_f32 v10, v14, v14
    v_fmac_f32 v11, v15, v15
    v_sub_f32 v12, v33, v16
    v_sub_f32 v13, v41, v17
    v_sub_f32 v14, v49, v18
    v_sub_f32 v15, v57, v19
    v_fmac_f32 v8, v12, v12
    v_fmac_f32 v9, v13, v13
    v_fmac_f32 v10, v14, v14
    v_fmac_f32 v11, v15, v15
    v_sub_f32 v12, v34, v16
    v_sub_f32 v13, v42, v17
    v_sub_f32 v14, v50, v18
    v_sub_f32 v15, v58, v19
    v_fmac_f32 v8, v12, v12
    v_fmac_f32 v9, v13, v13
    v_fmac_f32 v10, v14, v14
    v_fmac_f32 v11, v15, v15
    v_sub_f32 v12, v35, v16
    v_sub_f32 v13, v43, v17
    v_sub_f32 v14, v51, v18
    v_sub_f32 v15, v59, v19
    v_fmac_f32 v8, v12, v12
    v_fmac_f32 v9, v13, v13
    v_fmac_f32 v10, v14, v14
    v_fmac_f32 v11, v15, v15
    v_sub_f32 v12, v36, v16
    v_sub_f32 v13, v44, v17
    v_sub_f32 v14, v52, v18
    v_sub_f32 v15, v60, v19
    v_fmac_f32 v8, v12, v12
    v_fmac_f32 v9, v13, v13
    v_fmac_f32 v10, v14, v14
    v_fmac_f32 v11, v15, v15
    v_sub_f32 v12, v37, v16
    v_sub_f32 v13, v45, v17
    v_sub_f32 v14, v53, v18
    v_sub_f32 v15, v61, v19
    v_fmac_f32 v8, v12, v12
    v_fmac_f32 v9, v13, v13
    v_fmac_f32 v10, v14, v14
    v_fmac_f32 v11, v15, v15
    v_sub_f32 v12, v38, v16
    v_sub_f32 v13, v46, v17
    v_sub_f32 v14, v54, v18
    v_sub_f32 v15, v62, v19
    v_fmac_f32 v8, v12, v12
    v_fmac_f32 v9, v13, v13
    v_fmac_f32 v10, v14, v14
    v_fmac_f32 v11, v15, v15
    v_sub_f32 v12, v39, v16
    v_sub_f32 v13, v47, v17
    v_sub_f32 v14, v55, v18
    v_sub_f32 v15, v63, v19
    v_fmac_f32 v8, v12, v12
    v_fmac_f32 v9, v13, v13
    v_fmac_f32 v10, v14, v14
    v_fmac_f32 v11, v15, v15
    s_mov_b64 exec, s[16:17]
    s_nop 1
    v_add_f32_dpp v8, v8, v8 row_shr:1 row_mask:0xf bank_mask:0xf bound_ctrl:0
    v_add_f32_dpp v9, v9, v9 row_shr:1 row_mask:0xf bank_mask:0xf bound_ctrl:0
    v_add_f32_dpp v10, v10, v10 row_shr:1 row_mask:0xf bank_mask:0xf bound_ctrl:0
    v_add_f32_dpp v11, v11, v11 row_shr:1 row_mask:0xf bank_mask:0xf bound_ctrl:0
    v_add_f32_dpp v8, v8, v8 row_shr:2 row_mask:0xf bank_mask:0xf bound_ctrl:0
    v_add_f32_dpp v9, v9, v9 row_shr:2 row_mask:0xf bank_mask:0xf bound_ctrl:0
    v_add_f32_dpp v10, v10, v10 row_shr:2 row_mask:0xf bank_mask:0xf bound_ctrl:0
    v_add_f32_dpp v11, v11, v11 row_shr:2 row_mask:0xf bank_mask:0xf bound_ctrl:0
    v_add_f32_dpp v8, v8, v8 row_shr:4 row_mask:0xf bank_mask:0xf bound_ctrl:0
    v_add_f32_dpp v9, v9, v9 row_shr:4 row_mask:0xf bank_mask:0xf bound_ctrl:0
    v_add_f32_dpp v10, v10, v10 row_shr:4 row_mask:0xf bank_mask:0xf bound_ctrl:0
    v_add_f32_dpp v11, v11, v11 row_shr:4 row_mask:0xf bank_mask:0xf bound_ctrl:0
    v_add_f32_dpp v8, v8, v8 row_shr:8 row_mask:0xf bank_mask:0xf bound_ctrl:0
    v_add_f32_dpp v9, v9, v9 row_shr:8 row_mask:0xf bank_mask:0xf bound_ctrl:0
    v_add_f32_dpp v10, v10, v10 row_shr:8 row_mask:0xf bank_mask:0xf bound_ctrl:0
    v_add_f32_dpp v11, v11, v11 row_shr:8 row_mask:0xf bank_mask:0xf bound_ctrl:0
    v_add_f32_dpp v8, v8, v8 row_bcast:15 row_mask:0xa bank_mask:0xf
    v_add_f32_dpp v9, v9, v9 row_bcast:15 row_mask:0xa bank_mask:0xf
    v_add_f32_dpp v10, v10, v10 row_bcast:15 row_mask:0xa bank_mask:0xf
    v_add_f32_dpp v11, v11, v11 row_bcast:15 row_mask:0xa bank_mask:0xf
    v_add_f32_dpp v8, v8, v8 row_bcast:31 row_mask:0xc bank_mask:0xf
    v_add_f32_dpp v9, v9, v9 row_bcast:31 row_mask:0xc bank_mask:0xf
    v_add_f32_dpp v10, v10, v10 row_bcast:31 row_mask:0xc bank_mask:0xf
    v_add_f32_dpp v11, v11, v11 row_bcast:31 row_mask:0xc bank_mask:0xf
    v_readlane_b32 s24, v8, 63
    v_readlane_b32 s25, v9, 63
    v_readlane_b32 s26, v10, 63
    v_readlane_b32 s27, v11, 63
    v_mov_b32 v12, s24
    v_mov_b32 v13, s25
    v_mov_b32 v14, s26
    v_mov_b32 v15, s27
    v_mul_f32 v20, s20, v12
    v_mul_f32 v21, s20, v13
    v_mul_f32 v22, s20, v14
    v_mul_f32 v23, s20, v15
    v_fma_f32 v64, -v20, s21, v12
    v_fma_f32 v65, -v21, s21, v13
    v_fma_f32 v66, -v22, s21, v14
    v_fma_f32 v67, -v23, s21, v15
    v_fma_f32 v20, v64, s20, v20
    v_fma_f32 v21, v65, s20, v21
    v_fma_f32 v22, v66, s20, v22
    v_fma_f32 v23, v67, s20, v23
    v_cvt_pk_bf16_f32 v20, v20, v20
    v_cvt_pk_bf16_f32 v21, v21, v21
    v_cvt_pk_bf16_f32 v22, v22, v22
    v_cvt_pk_bf16_f32 v23, v23, v23
    v_cvt_pk_bf16_f32 v16, v16, v16
    v_cvt_pk_bf16_f32 v17, v17, v17
    v_cvt_pk_bf16_f32 v18, v18, v18
    v_cvt_pk_bf16_f32 v19, v19, v19
    v_lshlrev_b32 v20, 16, v20
    v_lshlrev_b32 v21, 16, v21
    v_lshlrev_b32 v22, 16, v22
    v_lshlrev_b32 v23, 16, v23
    v_lshlrev_b32 v16, 16, v16
    v_lshlrev_b32 v17, 16, v17
    v_lshlrev_b32 v18, 16, v18
    v_lshlrev_b32 v19, 16, v19
    v_add_f32 v20, s22, v20
    v_add_f32 v21, s22, v21
    v_add_f32 v22, s22, v22
    v_add_f32 v23, s22, v23
    v_cvt_pk_bf16_f32 v20, v20, v20
    v_cvt_pk_bf16_f32 v21, v21, v21
    v_cvt_pk_bf16_f32 v22, v22, v22
    v_cvt_pk_bf16_f32 v23, v23, v23
    v_lshlrev_b32 v20, 16, v20
    v_lshlrev_b32 v21, 16, v21
    v_lshlrev_b32 v22, 16, v22
    v_lshlrev_b32 v23, 16, v23
    v_sqrt_f32 v64, v20
    v_sqrt_f32 v65, v21
    v_sqrt_f32 v66, v22
    v_sqrt_f32 v67, v23
    v_sub_f32 v32, v32, v16
    v_sub_f32 v40, v40, v17
    v_sub_f32 v48, v48, v18
    v_sub_f32 v56, v56, v19
    v_sub_f32 v33, v33, v16
    v_sub_f32 v41, v41, v17
    v_sub_f32 v49, v49, v18
    v_sub_f32 v57, v57, v19
    v_sub_f32 v34, v34, v16
    v_sub_f32 v42, v42, v17
    v_sub_f32 v50, v50, v18
    v_sub_f32 v58, v58, v19
    v_sub_f32 v35, v35, v16
    v_sub_f32 v43, v43, v17
    v_sub_f32 v51, v51, v18
    v_sub_f32 v59, v59, v19
    v_sub_f32 v36, v36, v16
    v_sub_f32 v44, v44, v17
    v_sub_f32 v52, v52, v18
    v_sub_f32 v60, v60, v19
    v_sub_f32 v37, v37, v16
    v_sub_f32 v45, v45, v17
    v_sub_f32 v53, v53, v18
    v_sub_f32 v61, v61, v19
    v_sub_f32 v38, v38, v16
    v_sub_f32 v46, v46, v17
    v_sub_f32 v54, v54, v18
    v_sub_f32 v62, v62, v19
    v_sub_f32 v39, v39, v16
    v_sub_f32 v47, v47, v17
    v_sub_f32 v55, v55, v18
    v_sub_f32 v63, v63, v19
    v_rcp_f32 v68, v64
    v_rcp_f32 v69, v65
    v_rcp_f32 v70, v66
    v_rcp_f32 v71, v67
    v_fma_f32 v12, -v64, v64, v20
    v_fma_f32 v13, -v65, v65, v21
    v_fma_f32 v14, -v66, v66, v22
    v_fma_f32 v15, -v67, v67, v23
    v_mul_f32 v68, 0.5, v68
    v_mul_f32 v69, 0.5, v69
    v_mul_f32 v70, 0.5, v70
    v_mul_f32 v71, 0.5, v71
    v_fma_f32 v64, v12, v68, v64
    v_fma_f32 v65, v13, v69, v65
    v_fma_f32 v66, v14, v70, v66
    v_fma_f32 v67, v15, v71, v67
    v_cvt_pk_bf16_f32 v64, v64, v64
    v_cvt_pk_bf16_f32 v65, v65, v65
    v_cvt_pk_bf16_f32 v66, v66, v66
    v_cvt_pk_bf16_f32 v67, v67, v67
    v_lshlrev_b32 v64, 16, v64
    v_lshlrev_b32 v65, 16, v65
    v_lshlrev_b32 v66, 16, v66
    v_lshlrev_b32 v67, 16, v67
    v_rcp_f32 v68, v64
    v_rcp_f32 v69, v65
    v_rcp_f32 v70, v66
    v_rcp_f32 v71, v67
    v_cvt_pk_bf16_f32 v12, v32, v33
    v_cvt_pk_bf16_f32 v13, v40, v41
    v_cvt_pk_bf16_f32 v14, v48, v49
    v_cvt_pk_bf16_f32 v15, v56, v57
    v_lshlrev_b32 v32, 16, v12
    v_lshlrev_b32 v40, 16, v13
    v_lshlrev_b32 v48, 16, v14
    v_lshlrev_b32 v56, 16, v15
    v_and_b32 v33, 0xffff0000, v12
    v_and_b32 v41, 0xffff0000, v13
    v_and_b32 v49, 0xffff0000, v14
    v_and_b32 v57, 0xffff0000, v15
    v_cvt_pk_bf16_f32 v12, v34, v35
    v_cvt_pk_bf16_f32 v13, v42, v43
    v_cvt_pk_bf16_f32 v14, v50, v51
    v_cvt_pk_bf16_f32 v15, v58, v59
    v_lshlrev_b32 v34, 16, v12
    v_lshlrev_b32 v42, 16, v13
    v_lshlrev_b32 v50, 16, v14
    v_lshlrev_b32 v58, 16, v15
    v_and_b32 v35, 0xffff0000, v12
    v_and_b32 v43, 0xffff0000, v13
    v_and_b32 v51, 0xffff0000, v14
    v_and_b32 v59, 0xffff0000, v15
    v_cvt_pk_bf16_f32 v12, v36, v37
    v_cvt_pk_bf16_f32 v13, v44, v45
    v_cvt_pk_bf16_f32 v14, v52, v53
    v_cvt_pk_bf16_f32 v15, v60, v61
    v_lshlrev_b32 v36, 16, v12
    v_lshlrev_b32 v44, 16, v13
    v_lshlrev_b32 v52, 16, v14
    v_lshlrev_b32 v60, 16, v15
    v_and_b32 v37, 0xffff0000, v12
    v_and_b32 v45, 0xffff0000, v13
    v_and_b32 v53, 0xffff0000, v14
    v_and_b32 v61, 0xffff0000, v15
    v_cvt_pk_bf16_f32 v12, v38, v39
    v_cvt_pk_bf16_f32 v13, v46, v47
    v_cvt_pk_bf16_f32 v14, v54, v55
    v_cvt_pk_bf16_f32 v15, v62, v63
    v_lshlrev_b32 v38, 16, v12
    v_lshlrev_b32 v46, 16, v13
    v_lshlrev_b32 v54, 16, v14
    v_lshlrev_b32 v62, 16, v15
    v_and_b32 v39, 0xffff0000, v12
    v_and_b32 v47, 0xffff0000, v13
    v_and_b32 v55, 0xffff0000, v14
    v_and_b32 v63, 0xffff0000, v15
    v_fma_f32 v12, -v64, v68, 1.0
    v_fma_f32 v13, -v65, v69, 1.0
    v_fma_f32 v14, -v66, v70, 1.0
    v_fma_f32 v15, -v67, v71, 1.0
    v_fma_f32 v68, v12, v68, v68
    v_fma_f32 v69, v13, v69, v69
    v_fma_f32 v70, v14, v70, v70
    v_fma_f32 v71, v15, v71, v71
    v_mul_f32 v12, v32, v68
    v_mul_f32 v13, v40, v69
    v_mul_f32 v14, v48, v70
    v_mul_f32 v15, v56, v71
    v_fma_f32 v20, -v12, v64, v32
    v_fma_f32 v21, -v13, v65, v40
    v_fma_f32 v22, -v14, v66, v48
    v_fma_f32 v23, -v15, v67, v56
    v_fma_f32 v32, v20, v68, v12
    v_fma_f32 v40, v21, v69, v13
    v_fma_f32 v48, v22, v70, v14
    v_fma_f32 v56, v23, v71, v15
    v_mul_f32 v12, v33, v68
    v_mul_f32 v13, v41, v69
    v_mul_f32 v14, v49, v70
    v_mul_f32 v15, v57, v71
    v_fma_f32 v20, -v12, v64, v33
    v_fma_f32 v21, -v13, v65, v41
    v_fma_f32 v22, -v14, v66, v49
    v_fma_f32 v23, -v15, v67, v57
    v_fma_f32 v33, v20, v68, v12
    v_fma_f32 v41, v21, v69, v13
    v_fma_f32 v49, v22, v70, v14
    v_fma_f32 v57, v23, v71, v15
    v_mul_f32 v12, v34, v68
    v_mul_f32 v13, v42, v69
    v_mul_f32 v14, v50, v70
    v_mul_f32 v15, v58, v71
    v_fma_f32 v20, -v12, v64, v34
    v_fma_f32 v21, -v13, v65, v42
    v_fma_f32 v22, -v14, v66, v50
    v_fma_f32 v23, -v15, v67, v58
    v_fma_f32 v34, v20, v68, v12
    v_fma_f32 v42, v21, v69, v13
    v_fma_f32 v50, v22, v70, v14
    v_fma_f32 v58, v23, v71, v15
    v_mul_f32 v12, v35, v68
    v_mul_f32 v13, v43, v69
    v_mul_f32 v14, v51, v70
    v_mul_f32 v15, v59, v71
    v_fma_f32 v20, -v12, v64, v35
    v_fma_f32 v21, -v13, v65, v43
    v_fma_f32 v22, -v14, v66, v51
    v_fma_f32 v23, -v15, v67, v59
    v_fma_f32 v35, v20, v68, v12
    v_fma_f32 v43, v21, v69, v13
    v_fma_f32 v51, v22, v70, v14
    v_fma_f32 v59, v23, v71, v15
    v_mul_f32 v12, v36, v68
    v_mul_f32 v13, v44, v69
    v_mul_f32 v14, v52, v70
    v_mul_f32 v15, v60, v71
    v_fma_f32 v20, -v12, v64, v36
    v_fma_f32 v21, -v13, v65, v44
    v_fma_f32 v22, -v14, v66, v52
    v_fma_f32 v23, -v15, v67, v60
    v_fma_f32 v36, v20, v68, v12
    v_fma_f32 v44, v21, v69, v13
    v_fma_f32 v52, v22, v70, v14
    v_fma_f32 v60, v23, v71, v15
    v_mul_f32 v12, v37, v68
    v_mul_f32 v13, v45, v69
    v_mul_f32 v14, v53, v70
    v_mul_f32 v15, v61, v71
    v_fma_f32 v20, -v12, v64, v37
    v_fma_f32 v21, -v13, v65, v45
    v_fma_f32 v22, -v14, v66, v53
    v_fma_f32 v23, -v15, v67, v61
    v_fma_f32 v37, v20, v68, v12
    v_fma_f32 v45, v21, v69, v13
    v_fma_f32 v53, v22, v70, v14
    v_fma_f32 v61, v23, v71, v15
    v_mul_f32 v12, v38, v68
    v_mul_f32 v13, v46, v69
    v_mul_f32 v14, v54, v70
    v_mul_f32 v15, v62, v71
    v_fma_f32 v20, -v12, v64, v38
    v_fma_f32 v21, -v13, v65, v46
    v_fma_f32 v22, -v14, v66, v54
    v_fma_f32 v23, -v15, v67, v62
    v_fma_f32 v38, v20, v68, v12
    v_fma_f32 v46, v21, v69, v13
    v_fma_f32 v54, v22, v70, v14
    v_fma_f32 v62, v23, v71, v15
    v_mul_f32 v12, v39, v68
    v_mul_f32 v13, v47, v69
    v_mul_f32 v14, v55, v70
    v_mul_f32 v15, v63, v71
    v_fma_f32 v20, -v12, v64, v39
    v_fma_f32 v21, -v13, v65, v47
    v_fma_f32 v22, -v14, v66, v55
    v_fma_f32 v23, -v15, v67, v63
    v_fma_f32 v39, v20, v68, v12
    v_fma_f32 v47, v21, v69, v13
    v_fma_f32 v55, v22, v70, v14
    v_fma_f32 v63, v23, v71, v15
    v_cvt_pk_bf16_f32 v8, v32, v33
    v_cvt_pk_bf16_f32 v12, v40, v41
    v_cvt_pk_bf16_f32 v16, v48, v49
    v_cvt_pk_bf16_f32 v20, v56, v57
    v_cvt_pk_bf16_f32 v9, v34, v35
    v_cvt_pk_bf16_f32 v13, v42, v43
    v_cvt_pk_bf16_f32 v17, v50, v51
    v_cvt_pk_bf16_f32 v21, v58, v59
    v_cvt_pk_bf16_f32 v10, v36, v37
    v_cvt_pk_bf16_f32 v14, v44, v45
    v_cvt_pk_bf16_f32 v18, v52, v53
    v_cvt_pk_bf16_f32 v22, v60, v61
    v_cvt_pk_bf16_f32 v11, v38, v39
    v_cvt_pk_bf16_f32 v15, v46, v47
    v_cvt_pk_bf16_f32 v19, v54, v55
    v_cvt_pk_bf16_f32 v23, v62, v63
    v_lshlrev_b32 v30, 2, v1
    v_mul_u32_u24 v30, 896, v30
    v_lshl_add_u32 v30, v2, 4, v30
    s_mov_b64 exec, s[18:19]
    ds_write_b128 v29, v[8:11] offset:16384
    ds_write_b128 v29, v[12:15] offset:16400
    ds_write_b128 v29, v[16:19] offset:16416
    ds_write_b128 v29, v[20:23] offset:16432
    s_mov_b64 exec, s[16:17]
    s_waitcnt lgkmcnt(0)
    s_barrier
    v_lshlrev_b32 v4, 4, v0
    v_add_u32 v5, s7, v4
    ds_read_b128 v[8:11], v4 offset:16384
    ds_read_b128 v[12:15], v4 offset:20480
    ds_read_b128 v[16:19], v4 offset:24576
    v_cmp_gt_u32 vcc, 128, v0
    s_and_saveexec_b64 s[16:17], vcc
    ds_read_b128 v[20:23], v4 offset:28672
    v_add_u32 v6, 0x3000, v5
    s_waitcnt lgkmcnt(0)
    global_store_dwordx4 v6, v[20:23], s[14:15] sc1
    s_mov_b64 exec, s[16:17]
    v_add_u32 v6, 0x1000, v5
    v_add_u32 v7, 0x2000, v5
    s_waitcnt lgkmcnt(0)
    global_store_dwordx4 v5, v[8:11], s[14:15] sc1
    global_store_dwordx4 v6, v[12:15], s[14:15] sc1
    global_store_dwordx4 v7, v[16:19], s[14:15] sc1
    s_lshl_b32 s74, s3, 2
    s_waitcnt vmcnt(0) lgkmcnt(0)
    s_barrier
    s_cmp_lg_u32 s69, 0
    s_cbranch_scc1 PB_end_1
    s_cmp_lg_u32 s68, 0
    s_cbranch_scc1 N_ok_3
    s_waitcnt vmcnt(0)
    v_readfirstlane_b32 s68, v255
    s_cmp_lg_u32 s68, 0
    s_cbranch_scc1 N_ok_3
    v_mov_b32 v253, 0
N_poll_2:
    global_load_dword v254, v253, s[66:67] sc1
    s_waitcnt vmcnt(0)
    v_readfirstlane_b32 s68, v254
    s_cmp_lg_u32 s68, 0
    s_cbranch_scc1 N_ok_3
    s_sleep 4
    s_branch N_poll_2
N_ok_3:
    v_mov_b32 v254, s68
    s_mov_b64 s[72:73], exec
    s_mov_b64 exec, 1
    v_mov_b32 v253, s74
    global_store_dword v253, v254, s[70:71] sc1
    s_mov_b64 exec, s[72:73]
PB_end_1:
    s_branch A_g1
A_wtonly:
    s_sub_u32 s3, s2, 128
    s_mov_b32 s75, 96
    s_cmp_lt_u32 s3, 4
    s_cselect_b32 s75, 192, s75
    v_lshrrev_b32 v1, 3, v0
    v_and_b32 v2, 7, v0
    s_mov_b32 s80, s3
    s_mul_i32 s82, s80, 9363
    s_lshr_b32 s82, s82, 16
    s_mul_i32 s81, s82, 7
    s_sub_u32 s81, s80, s81
    s_and_b32 s83, s82, 1
    s_mul_i32 s83, s83, 7
    s_add_u32 s83, s83, s81
    s_lshl_b32 s83, s83, 2
    s_lshr_b32 s20, s82, 1
    s_lshl_b32 s20, s20, 6
    s_add_u32 s83, s83, s20
    s_add_u32 s83, s83, 1024
    s_add_u32 s84, s3, 96
    s_mul_i32 s86, s84, 9363
    s_lshr_b32 s86, s86, 16
    s_mul_i32 s85, s86, 7
    s_sub_u32 s85, s84, s85
    s_and_b32 s87, s86, 1
    s_mul_i32 s87, s87, 7
    s_add_u32 s87, s87, s85
    s_lshl_b32 s87, s87, 2
    s_lshr_b32 s20, s86, 1
    s_lshl_b32 s20, s20, 6
    s_add_u32 s87, s87, s20
    s_add_u32 s87, s87, 1024
    s_add_u32 s88, s3, s75
    s_mul_i32 s90, s88, 9363
    s_lshr_b32 s90, s90, 16
    s_mul_i32 s89, s90, 7
    s_sub_u32 s89, s88, s89
    s_and_b32 s91, s90, 1
    s_mul_i32 s91, s91, 7
    s_add_u32 s91, s91, s89
    s_lshl_b32 s91, s91, 2
    s_lshr_b32 s20, s90, 1
    s_lshl_b32 s20, s20, 6
    s_add_u32 s91, s91, s20
    s_add_u32 s91, s91, 1024
    v_mul_u32_u24 v3, 3584, v1
    v_lshl_add_u32 v3, v2, 4, v3
    s_mul_i32 s20, s81, 229376
    s_lshl_b32 s21, s82, 7
    s_add_u32 s20, s20, s21
    v_add_u32 v4, s20, v3
    v_add_u32 v6, 114688, v4
    global_load_dwordx4 v[8:11], v4, s[56:57]
    global_load_dwordx4 v[12:15], v6, s[56:57]
    s_mul_i32 s20, s85, 229376
    s_lshl_b32 s21, s86, 7
    s_add_u32 s20, s20, s21
    v_add_u32 v4, s20, v3
    v_add_u32 v6, 114688, v4
    global_load_dwordx4 v[16:19], v4, s[56:57]
    global_load_dwordx4 v[20:23], v6, s[56:57]
    s_mul_i32 s20, s89, 229376
    s_lshl_b32 s21, s90, 7
    s_add_u32 s20, s20, s21
    v_add_u32 v4, s20, v3
    v_add_u32 v6, 114688, v4
    global_load_dwordx4 v[24:27], v4, s[56:57]
    global_load_dwordx4 v[28:31], v6, s[56:57]
    s_mov_b32 s4, s3
    s_mul_i32 s6, s4, 2341
    s_lshr_b32 s6, s6, 16
    s_mul_i32 s5, s6, 28
    s_sub_u32 s5, s4, s5
    s_lshl_b32 s7, s6, 7
    s_lshl_b32 s20, s5, 2
    s_add_u32 s7, s7, s20
    s_add_u32 s7, s7, 2048
    s_add_u32 s8, s3, 96
    s_mul_i32 s10, s8, 2341
    s_lshr_b32 s10, s10, 16
    s_mul_i32 s9, s10, 28
    s_sub_u32 s9, s8, s9
    s_lshl_b32 s11, s10, 7
    s_lshl_b32 s20, s9, 2
    s_add_u32 s11, s11, s20
    s_add_u32 s11, s11, 2048
    s_add_u32 s12, s3, s75
    s_mul_i32 s14, s12, 2341
    s_lshr_b32 s14, s14, 16
    s_mul_i32 s13, s14, 28
    s_sub_u32 s13, s12, s13
    s_lshl_b32 s15, s14, 7
    s_lshl_b32 s20, s13, 2
    s_add_u32 s15, s15, s20
    s_add_u32 s15, s15, 2048
    v_lshlrev_b32 v56, 7, v1
    v_lshl_add_u32 v56, v2, 4, v56
    s_waitcnt vmcnt(4)
    ds_write_b128 v56, v[8:11] offset:0
    ds_write_b128 v56, v[12:15] offset:4096
    s_waitcnt vmcnt(2)
    ds_write_b128 v56, v[16:19] offset:8192
    ds_write_b128 v56, v[20:23] offset:12288
    s_waitcnt vmcnt(0)
    ds_write_b128 v56, v[24:27] offset:16384
    ds_write_b128 v56, v[28:31] offset:20480
    v_mul_u32_u24 v3, 896, v1
    v_lshl_add_u32 v3, v2, 4, v3
    s_mul_i32 s20, s5, 57344
    s_lshl_b32 s21, s6, 7
    s_add_u32 s20, s20, s21
    v_add_u32 v4, s20, v3
    v_add_u32 v6, 28672, v4
    global_load_dwordx4 v[32:35], v4, s[58:59]
    global_load_dwordx4 v[36:39], v6, s[58:59]
    s_mul_i32 s20, s9, 57344
    s_lshl_b32 s21, s10, 7
    s_add_u32 s20, s20, s21
    v_add_u32 v4, s20, v3
    v_add_u32 v6, 28672, v4
    global_load_dwordx4 v[40:43], v4, s[58:59]
    global_load_dwordx4 v[44:47], v6, s[58:59]
    s_mul_i32 s20, s13, 57344
    s_lshl_b32 s21, s14, 7
    s_add_u32 s20, s20, s21
    v_add_u32 v4, s20, v3
    v_add_u32 v6, 28672, v4
    global_load_dwordx4 v[48:51], v4, s[58:59]
    global_load_dwordx4 v[52:55], v6, s[58:59]
    s_waitcnt lgkmcnt(0)
    s_barrier
    v_and_b32 v1, 15, v0
    v_bfe_u32 v2, v0, 4, 2
    v_lshrrev_b32 v3, 6, v0
    s_add_u32 s22, s64, 4194304
    s_addc_u32 s23, s65, 0
    v_lshrrev_b32 v4, 2, v1
    v_lshlrev_b32 v4, 4, v4
    v_lshl_add_u32 v4, v3, 2, v4
    v_and_b32 v6, 3, v1
    v_add_u32 v4, v4, v6
    v_lshlrev_b32 v5, 10, v2
    v_lshl_add_u32 v5, v4, 1, v5
    v_mul_u32_u24 v7, 14336, v3
    v_and_b32 v4, 63, v0
    v_lshl_add_u32 v7, v4, 4, v7
    ds_read_u16 v64, v5 offset:0
    ds_read_u16 v65, v5 offset:128
    ds_read_u16 v66, v5 offset:256
    ds_read_u16 v67, v5 offset:384
    ds_read_u16 v68, v5 offset:512
    ds_read_u16 v69, v5 offset:640
    ds_read_u16 v70, v5 offset:768
    ds_read_u16 v71, v5 offset:896
    s_waitcnt lgkmcnt(0)
    ds_read_u16 v72, v5 offset:4096
    ds_read_u16 v73, v5 offset:4224
    ds_read_u16 v74, v5 offset:4352
    ds_read_u16 v75, v5 offset:4480
    ds_read_u16 v76, v5 offset:4608
    ds_read_u16 v77, v5 offset:4736
    ds_read_u16 v78, v5 offset:4864
    ds_read_u16 v79, v5 offset:4992
    s_mul_i32 s20, s82, 57344
    s_lshl_b32 s21, s81, 11
    s_add_u32 s20, s20, s21
    v_add_u32 v6, s20, v7
    s_waitcnt lgkmcnt(0)
    v_lshl_or_b32 v8, v65, 16, v64
    v_lshl_or_b32 v9, v67, 16, v66
    v_lshl_or_b32 v10, v69, 16, v68
    v_lshl_or_b32 v11, v71, 16, v70
    v_lshl_or_b32 v12, v73, 16, v72
    v_lshl_or_b32 v13, v75, 16, v74
    v_lshl_or_b32 v14, v77, 16, v76
    v_lshl_or_b32 v15, v79, 16, v78
    global_store_dwordx4 v6, v[8:11], s[22:23] sc1
    global_store_dwordx4 v6, v[12:15], s[22:23] offset:1024 sc1
    ds_read_u16 v64, v5 offset:8192
    ds_read_u16 v65, v5 offset:8320
    ds_read_u16 v66, v5 offset:8448
    ds_read_u16 v67, v5 offset:8576
    ds_read_u16 v68, v5 offset:8704
    ds_read_u16 v69, v5 offset:8832
    ds_read_u16 v70, v5 offset:8960
    ds_read_u16 v71, v5 offset:9088
    s_waitcnt lgkmcnt(0)
    ds_read_u16 v72, v5 offset:12288
    ds_read_u16 v73, v5 offset:12416
    ds_read_u16 v74, v5 offset:12544
    ds_read_u16 v75, v5 offset:12672
    ds_read_u16 v76, v5 offset:12800
    ds_read_u16 v77, v5 offset:12928
    ds_read_u16 v78, v5 offset:13056
    ds_read_u16 v79, v5 offset:13184
    s_mul_i32 s20, s86, 57344
    s_lshl_b32 s21, s85, 11
    s_add_u32 s20, s20, s21
    v_add_u32 v6, s20, v7
    s_waitcnt lgkmcnt(0)
    v_lshl_or_b32 v16, v65, 16, v64
    v_lshl_or_b32 v17, v67, 16, v66
    v_lshl_or_b32 v18, v69, 16, v68
    v_lshl_or_b32 v19, v71, 16, v70
    v_lshl_or_b32 v20, v73, 16, v72
    v_lshl_or_b32 v21, v75, 16, v74
    v_lshl_or_b32 v22, v77, 16, v76
    v_lshl_or_b32 v23, v79, 16, v78
    global_store_dwordx4 v6, v[16:19], s[22:23] sc1
    global_store_dwordx4 v6, v[20:23], s[22:23] offset:1024 sc1
    ds_read_u16 v64, v5 offset:16384
    ds_read_u16 v65, v5 offset:16512
    ds_read_u16 v66, v5 offset:16640
    ds_read_u16 v67, v5 offset:16768
    ds_read_u16 v68, v5 offset:16896
    ds_read_u16 v69, v5 offset:17024
    ds_read_u16 v70, v5 offset:17152
    ds_read_u16 v71, v5 offset:17280
    s_waitcnt lgkmcnt(0)
    ds_read_u16 v72, v5 offset:20480
    ds_read_u16 v73, v5 offset:20608
    ds_read_u16 v74, v5 offset:20736
    ds_read_u16 v75, v5 offset:20864
    ds_read_u16 v76, v5 offset:20992
    ds_read_u16 v77, v5 offset:21120
    ds_read_u16 v78, v5 offset:21248
    ds_read_u16 v79, v5 offset:21376
    s_mul_i32 s20, s90, 57344
    s_lshl_b32 s21, s89, 11
    s_add_u32 s20, s20, s21
    v_add_u32 v6, s20, v7
    s_waitcnt lgkmcnt(0)
    v_lshl_or_b32 v24, v65, 16, v64
    v_lshl_or_b32 v25, v67, 16, v66
    v_lshl_or_b32 v26, v69, 16, v68
    v_lshl_or_b32 v27, v71, 16, v70
    v_lshl_or_b32 v28, v73, 16, v72
    v_lshl_or_b32 v29, v75, 16, v74
    v_lshl_or_b32 v30, v77, 16, v76
    v_lshl_or_b32 v31, v79, 16, v78
    global_store_dwordx4 v6, v[24:27], s[22:23] sc1
    global_store_dwordx4 v6, v[28:31], s[22:23] offset:1024 sc1
    s_waitcnt vmcnt(0) lgkmcnt(0)
    s_barrier
    s_cmp_lg_u32 s69, 0
    s_cbranch_scc1 PB_end_4
    s_cmp_lg_u32 s68, 0
    s_cbranch_scc1 N_ok_6
    s_waitcnt vmcnt(0)
    v_readfirstlane_b32 s68, v255
    s_cmp_lg_u32 s68, 0
    s_cbranch_scc1 N_ok_6
    v_mov_b32 v253, 0
N_poll_5:
    global_load_dword v254, v253, s[66:67] sc1
    s_waitcnt vmcnt(0)
    v_readfirstlane_b32 s68, v254
    s_cmp_lg_u32 s68, 0
    s_cbranch_scc1 N_ok_6
    s_sleep 4
    s_branch N_poll_5
N_ok_6:
    v_mov_b32 v254, s68
    s_mov_b64 s[72:73], exec
    s_mov_b64 exec, 1
    v_mov_b32 v253, s83
    global_store_dword v253, v254, s[70:71] sc1
    v_mov_b32 v253, s87
    global_store_dword v253, v254, s[70:71] sc1
    v_mov_b32 v253, s91
    global_store_dword v253, v254, s[70:71] sc1
    s_mov_b64 exec, s[72:73]
PB_end_4:
    ds_write_b128 v56, v[32:35] offset:24576
    ds_write_b128 v56, v[36:39] offset:28672
    ds_write_b128 v56, v[40:43] offset:32768
    ds_write_b128 v56, v[44:47] offset:36864
    ds_write_b128 v56, v[48:51] offset:40960
    ds_write_b128 v56, v[52:55] offset:45056
    s_waitcnt lgkmcnt(0)
    s_barrier
    s_add_u32 s22, s64, 6291456
    s_addc_u32 s23, s65, 0
    v_lshl_add_u32 v4, v3, 4, v1
    v_lshlrev_b32 v5, 10, v2
    v_lshl_add_u32 v5, v4, 1, v5
    v_mul_u32_u24 v7, 57344, v3
    v_and_b32 v4, 63, v0
    v_lshl_add_u32 v7, v4, 4, v7
    ds_read_u16 v64, v5 offset:24576
    ds_read_u16 v65, v5 offset:24704
    ds_read_u16 v66, v5 offset:24832
    ds_read_u16 v67, v5 offset:24960
    ds_read_u16 v68, v5 offset:25088
    ds_read_u16 v69, v5 offset:25216
    ds_read_u16 v70, v5 offset:25344
    ds_read_u16 v71, v5 offset:25472
    s_waitcnt lgkmcnt(0)
    ds_read_u16 v72, v5 offset:28672
    ds_read_u16 v73, v5 offset:28800
    ds_read_u16 v74, v5 offset:28928
    ds_read_u16 v75, v5 offset:29056
    ds_read_u16 v76, v5 offset:29184
    ds_read_u16 v77, v5 offset:29312
    ds_read_u16 v78, v5 offset:29440
    ds_read_u16 v79, v5 offset:29568
    s_mul_i32 s20, s6, 229376
    s_lshl_b32 s21, s5, 11
    s_add_u32 s20, s20, s21
    v_add_u32 v6, s20, v7
    s_waitcnt lgkmcnt(0)
    v_lshl_or_b32 v8, v65, 16, v64
    v_lshl_or_b32 v9, v67, 16, v66
    v_lshl_or_b32 v10, v69, 16, v68
    v_lshl_or_b32 v11, v71, 16, v70
    v_lshl_or_b32 v12, v73, 16, v72
    v_lshl_or_b32 v13, v75, 16, v74
    v_lshl_or_b32 v14, v77, 16, v76
    v_lshl_or_b32 v15, v79, 16, v78
    global_store_dwordx4 v6, v[8:11], s[22:23] sc1
    global_store_dwordx4 v6, v[12:15], s[22:23] offset:1024 sc1
    ds_read_u16 v64, v5 offset:32768
    ds_read_u16 v65, v5 offset:32896
    ds_read_u16 v66, v5 offset:33024
    ds_read_u16 v67, v5 offset:33152
    ds_read_u16 v68, v5 offset:33280
    ds_read_u16 v69, v5 offset:33408
    ds_read_u16 v70, v5 offset:33536
    ds_read_u16 v71, v5 offset:33664
    s_waitcnt lgkmcnt(0)
    ds_read_u16 v72, v5 offset:36864
    ds_read_u16 v73, v5 offset:36992
    ds_read_u16 v74, v5 offset:37120
    ds_read_u16 v75, v5 offset:37248
    ds_read_u16 v76, v5 offset:37376
    ds_read_u16 v77, v5 offset:37504
    ds_read_u16 v78, v5 offset:37632
    ds_read_u16 v79, v5 offset:37760
    s_mul_i32 s20, s10, 229376
    s_lshl_b32 s21, s9, 11
    s_add_u32 s20, s20, s21
    v_add_u32 v6, s20, v7
    s_waitcnt lgkmcnt(0)
    v_lshl_or_b32 v16, v65, 16, v64
    v_lshl_or_b32 v17, v67, 16, v66
    v_lshl_or_b32 v18, v69, 16, v68
    v_lshl_or_b32 v19, v71, 16, v70
    v_lshl_or_b32 v20, v73, 16, v72
    v_lshl_or_b32 v21, v75, 16, v74
    v_lshl_or_b32 v22, v77, 16, v76
    v_lshl_or_b32 v23, v79, 16, v78
    global_store_dwordx4 v6, v[16:19], s[22:23] sc1
    global_store_dwordx4 v6, v[20:23], s[22:23] offset:1024 sc1
    ds_read_u16 v64, v5 offset:40960
    ds_read_u16 v65, v5 offset:41088
    ds_read_u16 v66, v5 offset:41216
    ds_read_u16 v67, v5 offset:41344
    ds_read_u16 v68, v5 offset:41472
    ds_read_u16 v69, v5 offset:41600
    ds_read_u16 v70, v5 offset:41728
    ds_read_u16 v71, v5 offset:41856
    s_waitcnt lgkmcnt(0)
    ds_read_u16 v72, v5 offset:45056
    ds_read_u16 v73, v5 offset:45184
    ds_read_u16 v74, v5 offset:45312
    ds_read_u16 v75, v5 offset:45440
    ds_read_u16 v76, v5 offset:45568
    ds_read_u16 v77, v5 offset:45696
    ds_read_u16 v78, v5 offset:45824
    ds_read_u16 v79, v5 offset:45952
    s_mul_i32 s20, s14, 229376
    s_lshl_b32 s21, s13, 11
    s_add_u32 s20, s20, s21
    v_add_u32 v6, s20, v7
    s_waitcnt lgkmcnt(0)
    v_lshl_or_b32 v24, v65, 16, v64
    v_lshl_or_b32 v25, v67, 16, v66
    v_lshl_or_b32 v26, v69, 16, v68
    v_lshl_or_b32 v27, v71, 16, v70
    v_lshl_or_b32 v28, v73, 16, v72
    v_lshl_or_b32 v29, v75, 16, v74
    v_lshl_or_b32 v30, v77, 16, v76
    v_lshl_or_b32 v31, v79, 16, v78
    global_store_dwordx4 v6, v[24:27], s[22:23] sc1
    global_store_dwordx4 v6, v[28:31], s[22:23] offset:1024 sc1
    s_waitcnt vmcnt(0) lgkmcnt(0)
    s_barrier
    s_cmp_lg_u32 s69, 0
    s_cbranch_scc1 PB_end_7
    s_cmp_lg_u32 s68, 0
    s_cbranch_scc1 N_ok_9
    s_waitcnt vmcnt(0)
    v_readfirstlane_b32 s68, v255
    s_cmp_lg_u32 s68, 0
    s_cbranch_scc1 N_ok_9
    v_mov_b32 v253, 0
N_poll_8:
    global_load_dword v254, v253, s[66:67] sc1
    s_waitcnt vmcnt(0)
    v_readfirstlane_b32 s68, v254
    s_cmp_lg_u32 s68, 0
    s_cbranch_scc1 N_ok_9
    s_sleep 4
    s_branch N_poll_8
N_ok_9:
    v_mov_b32 v254, s68
    s_mov_b64 s[72:73], exec
    s_mov_b64 exec, 1
    v_mov_b32 v253, s7
    global_store_dword v253, v254, s[70:71] sc1
    v_mov_b32 v253, s11
    global_store_dword v253, v254, s[70:71] sc1
    v_mov_b32 v253, s15
    global_store_dword v253, v254, s[70:71] sc1
    s_mov_b64 exec, s[72:73]
PB_end_7:
A_g1:
    s_setprio 0
    v_and_b32 v1, 15, v0
    v_bfe_u32 v2, v0, 4, 2
    v_lshrrev_b32 v3, 6, v0
    s_and_b32 s10, s2, 7
    s_lshr_b32 s3, s2, 3
    s_mul_i32 s8, s3, 9363
    s_lshr_b32 s8, s8, 16
    s_mul_i32 s9, s8, 7
    s_sub_u32 s9, s3, s9
    s_and_b32 s11, s10, 1
    s_mul_i32 s11, s11, 7
    s_add_u32 s9, s9, s11
    s_lshr_b32 s10, s10, 1
    s_lshl_b32 s10, s10, 2
    s_add_u32 s8, s8, s10
    s_lshl_b32 s76, s8, 5
    s_lshl_b32 s77, s9, 6
    s_add_u32 s77, s77, 1024
    s_lshl_b32 s74, s8, 6
    s_lshl_b32 s10, s9, 2
    s_add_u32 s74, s74, s10
    s_add_u32 s74, s74, 3072
    s_cmp_lg_u32 s69, 0
    s_cbranch_scc1 W_end_10
    s_cmp_lg_u32 s68, 0
    s_cbranch_scc1 N_ok_12
    s_waitcnt vmcnt(0)
    v_readfirstlane_b32 s68, v255
    s_cmp_lg_u32 s68, 0
    s_cbranch_scc1 N_ok_12
    v_mov_b32 v253, 0
N_poll_11:
    global_load_dword v254, v253, s[66:67] sc1
    s_waitcnt vmcnt(0)
    v_readfirstlane_b32 s68, v254
    s_cmp_lg_u32 s68, 0
    s_cbranch_scc1 N_ok_12
    s_sleep 4
    s_branch N_poll_11
N_ok_12:
    v_and_b32 v253, 63, v0
    v_min_u32 v253, 13, v253
    v_lshl_add_u32 v253, v253, 2, s77
W_poll_13:
    global_load_dword v254, v253, s[70:71] sc1
    s_waitcnt vmcnt(0)
    v_cmp_ne_u32 vcc, s68, v254
    s_cmp_eq_u64 vcc, 0
    s_cbranch_scc1 W_ok_14
    s_sleep 3
    s_branch W_poll_13
W_ok_14:
W_end_10:
    s_barrier
    s_add_u32 s4, s64, 4194304
    s_addc_u32 s5, s65, 0
    s_add_u32 s6, s64, 0
    s_addc_u32 s7, s65, 0
    s_lshl_b32 s9, s9, 7
    s_lshl_b32 s8, s8, 7
    v_and_b32 v4, 1, v3
    v_lshl_add_u32 v4, v4, 6, s9
    v_lshrrev_b32 v5, 1, v3
    v_lshl_add_u32 v5, v5, 6, s8
    v_and_b32 v7, 63, v0
    v_lshlrev_b32 v7, 4, v7
    s_mul_i32 s11, s8, 896
    v_mul_u32_u24 v6, 896, v4
    v_add_u32 v8, v6, v7
    v_add_u32 v9, 14336, v8
    v_add_u32 v10, 28672, v8
    v_add_u32 v11, 43008, v8
    v_mul_u32_u24 v6, 28672, v3
    v_add_u32 v6, v6, v7
    v_add_u32 v12, s11, v6
    v_add_u32 v13, 14336, v12
    s_lshl_b32 s12, s69, 11
    v_lshrrev_b32 v14, 1, v3
    v_lshl_add_u32 v14, v14, 12, v7
    global_load_dwordx4 v[144:147], v8, s[4:5] offset:0 sc1
    global_load_dwordx4 v[148:151], v9, s[4:5] offset:0 sc1
    global_load_dwordx4 v[152:155], v10, s[4:5] offset:0 sc1
    global_load_dwordx4 v[156:159], v11, s[4:5] offset:0 sc1
    global_load_dwordx4 v[160:163], v8, s[4:5] offset:1024 sc1
    global_load_dwordx4 v[164:167], v9, s[4:5] offset:1024 sc1
    global_load_dwordx4 v[168:171], v10, s[4:5] offset:1024 sc1
    global_load_dwordx4 v[172:175], v11, s[4:5] offset:1024 sc1
    global_load_dwordx4 v[176:179], v8, s[4:5] offset:2048 sc1
    global_load_dwordx4 v[180:183], v9, s[4:5] offset:2048 sc1
    global_load_dwordx4 v[184:187], v10, s[4:5] offset:2048 sc1
    global_load_dwordx4 v[188:191], v11, s[4:5] offset:2048 sc1
    global_load_dwordx4 v[192:195], v8, s[4:5] offset:3072 sc1
    global_load_dwordx4 v[196:199], v9, s[4:5] offset:3072 sc1
    global_load_dwordx4 v[200:203], v10, s[4:5] offset:3072 sc1
    global_load_dwordx4 v[204:207], v11, s[4:5] offset:3072 sc1
    s_add_u32 s4, s4, 4096
    s_addc_u32 s5, s5, 0
    global_load_dwordx4 v[208:211], v8, s[4:5] offset:0 sc1
    global_load_dwordx4 v[212:215], v9, s[4:5] offset:0 sc1
    global_load_dwordx4 v[216:219], v10, s[4:5] offset:0 sc1
    global_load_dwordx4 v[220:223], v11, s[4:5] offset:0 sc1
    global_load_dwordx4 v[224:227], v8, s[4:5] offset:1024 sc1
    global_load_dwordx4 v[228:231], v9, s[4:5] offset:1024 sc1
    global_load_dwordx4 v[232:235], v10, s[4:5] offset:1024 sc1
    global_load_dwordx4 v[236:239], v11, s[4:5] offset:1024 sc1
    s_cmp_lg_u32 s69, 0
    s_cbranch_scc1 W_end_15
    s_cmp_lg_u32 s68, 0
    s_cbranch_scc1 N_ok_17
    s_waitcnt vmcnt(0)
    v_readfirstlane_b32 s68, v255
    s_cmp_lg_u32 s68, 0
    s_cbranch_scc1 N_ok_17
    v_mov_b32 v253, 0
N_poll_16:
    global_load_dword v254, v253, s[66:67] sc1
    s_waitcnt vmcnt(0)
    v_readfirstlane_b32 s68, v254
    s_cmp_lg_u32 s68, 0
    s_cbranch_scc1 N_ok_17
    s_sleep 4
    s_branch N_poll_16
N_ok_17:
    v_and_b32 v253, 63, v0
    v_min_u32 v253, 7, v253
    v_lshl_add_u32 v253, v253, 2, s76
W_poll_18:
    global_load_dword v254, v253, s[70:71] sc1
    s_waitcnt vmcnt(0)
    v_cmp_ne_u32 vcc, s68, v254
    s_cmp_eq_u64 vcc, 0
    s_cbranch_scc1 W_ok_19
    s_sleep 3
    s_branch W_poll_18
W_ok_19:
W_end_15:
    s_barrier
    s_add_u32 m0, s12, 0
    s_nop 0
    global_load_lds_dwordx4 v12, s[6:7] sc1
    s_add_u32 m0, s12, 1024
    s_nop 0
    global_load_lds_dwordx4 v13, s[6:7] sc1
    s_add_u32 s6, s6, 1024
    s_addc_u32 s7, s7, 0
    s_add_u32 m0, s12, 8192
    s_nop 0
    global_load_lds_dwordx4 v12, s[6:7] sc1
    s_add_u32 m0, s12, 9216
    s_nop 0
    global_load_lds_dwordx4 v13, s[6:7] sc1
    s_add_u32 s6, s6, 1024
    s_addc_u32 s7, s7, 0
    s_add_u32 m0, s12, 16384
    s_nop 0
    global_load_lds_dwordx4 v12, s[6:7] sc1
    s_add_u32 m0, s12, 17408
    s_nop 0
    global_load_lds_dwordx4 v13, s[6:7] sc1
    s_add_u32 s6, s6, 1024
    s_addc_u32 s7, s7, 0
    s_add_u32 m0, s12, 24576
    s_nop 0
    global_load_lds_dwordx4 v12, s[6:7] sc1
    s_add_u32 m0, s12, 25600
    s_nop 0
    global_load_lds_dwordx4 v13, s[6:7] sc1
    s_add_u32 s6, s6, 1024
    s_addc_u32 s7, s7, 0
    s_add_u32 m0, s12, 32768
    s_nop 0
    global_load_lds_dwordx4 v12, s[6:7] sc1
    s_add_u32 m0, s12, 33792
    s_nop 0
    global_load_lds_dwordx4 v13, s[6:7] sc1
    s_add_u32 s6, s6, 1024
    s_addc_u32 s7, s7, 0
    s_add_u32 m0, s12, 40960
    s_nop 0
    global_load_lds_dwordx4 v12, s[6:7] sc1
    s_add_u32 m0, s12, 41984
    s_nop 0
    global_load_lds_dwordx4 v13, s[6:7] sc1
    s_add_u32 s6, s6, 1024
    s_addc_u32 s7, s7, 0
    s_add_u32 m0, s12, 49152
    s_nop 0
    global_load_lds_dwordx4 v12, s[6:7] sc1
    s_add_u32 m0, s12, 50176
    s_nop 0
    global_load_lds_dwordx4 v13, s[6:7] sc1
    s_add_u32 s6, s6, 1024
    s_addc_u32 s7, s7, 0
    s_add_u32 m0, s12, 57344
    s_nop 0
    global_load_lds_dwordx4 v12, s[6:7] sc1
    s_add_u32 m0, s12, 58368
    s_nop 0
    global_load_lds_dwordx4 v13, s[6:7] sc1
    s_waitcnt vmcnt(14)
    s_barrier
    ds_read_b128 v[80:83], v14 offset:0
    ds_read_b128 v[84:87], v14 offset:1024
    ds_read_b128 v[88:91], v14 offset:2048
    ds_read_b128 v[92:95], v14 offset:3072
    s_waitcnt vmcnt(12) lgkmcnt(0)
    s_barrier
    s_add_u32 s6, s6, 1024
    s_addc_u32 s7, s7, 0
    s_add_u32 m0, s12, 0
    s_nop 0
    global_load_lds_dwordx4 v12, s[6:7] sc1
    s_add_u32 m0, s12, 1024
    s_nop 0
    global_load_lds_dwordx4 v13, s[6:7] sc1
    ds_read_b128 v[96:99], v14 offset:8192
    ds_read_b128 v[100:103], v14 offset:9216
    ds_read_b128 v[104:107], v14 offset:10240
    ds_read_b128 v[108:111], v14 offset:11264
    v_mfma_f32_16x16x32_bf16 v[16:19], v[144:147], v[80:83], 0
    v_mfma_f32_16x16x32_bf16 v[20:23], v[144:147], v[84:87], 0
    v_mfma_f32_16x16x32_bf16 v[24:27], v[144:147], v[88:91], 0
    v_mfma_f32_16x16x32_bf16 v[28:31], v[144:147], v[92:95], 0
    v_mfma_f32_16x16x32_bf16 v[32:35], v[148:151], v[80:83], 0
    v_mfma_f32_16x16x32_bf16 v[36:39], v[148:151], v[84:87], 0
    v_mfma_f32_16x16x32_bf16 v[40:43], v[148:151], v[88:91], 0
    v_mfma_f32_16x16x32_bf16 v[44:47], v[148:151], v[92:95], 0
    v_mfma_f32_16x16x32_bf16 v[48:51], v[152:155], v[80:83], 0
    v_mfma_f32_16x16x32_bf16 v[52:55], v[152:155], v[84:87], 0
    v_mfma_f32_16x16x32_bf16 v[56:59], v[152:155], v[88:91], 0
    v_mfma_f32_16x16x32_bf16 v[60:63], v[152:155], v[92:95], 0
    v_mfma_f32_16x16x32_bf16 v[64:67], v[156:159], v[80:83], 0
    v_mfma_f32_16x16x32_bf16 v[68:71], v[156:159], v[84:87], 0
    v_mfma_f32_16x16x32_bf16 v[72:75], v[156:159], v[88:91], 0
    v_mfma_f32_16x16x32_bf16 v[76:79], v[156:159], v[92:95], 0
    global_load_dwordx4 v[144:147], v8, s[4:5] offset:2048 sc1
    global_load_dwordx4 v[148:151], v9, s[4:5] offset:2048 sc1
    global_load_dwordx4 v[152:155], v10, s[4:5] offset:2048 sc1
    global_load_dwordx4 v[156:159], v11, s[4:5] offset:2048 sc1
    s_waitcnt vmcnt(16) lgkmcnt(0)
    s_barrier
    s_add_u32 s6, s6, 1024
    s_addc_u32 s7, s7, 0
    s_add_u32 m0, s12, 8192
    s_nop 0
    global_load_lds_dwordx4 v12, s[6:7] sc1
    s_add_u32 m0, s12, 9216
    s_nop 0
    global_load_lds_dwordx4 v13, s[6:7] sc1
    ds_read_b128 v[80:83], v14 offset:16384
    ds_read_b128 v[84:87], v14 offset:17408
    ds_read_b128 v[88:91], v14 offset:18432
    ds_read_b128 v[92:95], v14 offset:19456
    v_mfma_f32_16x16x32_bf16 v[16:19], v[160:163], v[96:99], v[16:19]
    v_mfma_f32_16x16x32_bf16 v[20:23], v[160:163], v[100:103], v[20:23]
    v_mfma_f32_16x16x32_bf16 v[24:27], v[160:163], v[104:107], v[24:27]
    v_mfma_f32_16x16x32_bf16 v[28:31], v[160:163], v[108:111], v[28:31]
    v_mfma_f32_16x16x32_bf16 v[32:35], v[164:167], v[96:99], v[32:35]
    v_mfma_f32_16x16x32_bf16 v[36:39], v[164:167], v[100:103], v[36:39]
    v_mfma_f32_16x16x32_bf16 v[40:43], v[164:167], v[104:107], v[40:43]
    v_mfma_f32_16x16x32_bf16 v[44:47], v[164:167], v[108:111], v[44:47]
    v_mfma_f32_16x16x32_bf16 v[48:51], v[168:171], v[96:99], v[48:51]
    v_mfma_f32_16x16x32_bf16 v[52:55], v[168:171], v[100:103], v[52:55]
    v_mfma_f32_16x16x32_bf16 v[56:59], v[168:171], v[104:107], v[56:59]
    v_mfma_f32_16x16x32_bf16 v[60:63], v[168:171], v[108:111], v[60:63]
    v_mfma_f32_16x16x32_bf16 v[64:67], v[172:175], v[96:99], v[64:67]
    v_mfma_f32_16x16x32_bf16 v[68:71], v[172:175], v[100:103], v[68:71]
    v_mfma_f32_16x16x32_bf16 v[72:75], v[172:175], v[104:107], v[72:75]
    v_mfma_f32_16x16x32_bf16 v[76:79], v[172:175], v[108:111], v[76:79]
    global_load_dwordx4 v[160:163], v8, s[4:5] offset:3072 sc1
    global_load_dwordx4 v[164:167], v9, s[4:5] offset:3072 sc1
    global_load_dwordx4 v[168:171], v10, s[4:5] offset:3072 sc1
    global_load_dwordx4 v[172:175], v11, s[4:5] offset:3072 sc1
    s_waitcnt vmcnt(20) lgkmcnt(0)
    s_barrier
    s_add_u32 s6, s6, 1024
    s_addc_u32 s7, s7, 0
    s_add_u32 m0, s12, 16384
    s_nop 0
    global_load_lds_dwordx4 v12, s[6:7] sc1
    s_add_u32 m0, s12, 17408
    s_nop 0
    global_load_lds_dwordx4 v13, s[6:7] sc1
    ds_read_b128 v[96:99], v14 offset:24576
    ds_read_b128 v[100:103], v14 offset:25600
    ds_read_b128 v[104:107], v14 offset:26624
    ds_read_b128 v[108:111], v14 offset:27648
    v_mfma_f32_16x16x32_bf16 v[16:19], v[176:179], v[80:83], v[16:19]
    v_mfma_f32_16x16x32_bf16 v[20:23], v[176:179], v[84:87], v[20:23]
    v_mfma_f32_16x16x32_bf16 v[24:27], v[176:179], v[88:91], v[24:27]
    v_mfma_f32_16x16x32_bf16 v[28:31], v[176:179], v[92:95], v[28:31]
    v_mfma_f32_16x16x32_bf16 v[32:35], v[180:183], v[80:83], v[32:35]
    v_mfma_f32_16x16x32_bf16 v[36:39], v[180:183], v[84:87], v[36:39]
    v_mfma_f32_16x16x32_bf16 v[40:43], v[180:183], v[88:91], v[40:43]
    v_mfma_f32_16x16x32_bf16 v[44:47], v[180:183], v[92:95], v[44:47]
    v_mfma_f32_16x16x32_bf16 v[48:51], v[184:187], v[80:83], v[48:51]
    v_mfma_f32_16x16x32_bf16 v[52:55], v[184:187], v[84:87], v[52:55]
    v_mfma_f32_16x16x32_bf16 v[56:59], v[184:187], v[88:91], v[56:59]
    v_mfma_f32_16x16x32_bf16 v[60:63], v[184:187], v[92:95], v[60:63]
    v_mfma_f32_16x16x32_bf16 v[64:67], v[188:191], v[80:83], v[64:67]
    v_mfma_f32_16x16x32_bf16 v[68:71], v[188:191], v[84:87], v[68:71]
    v_mfma_f32_16x16x32_bf16 v[72:75], v[188:191], v[88:91], v[72:75]
    v_mfma_f32_16x16x32_bf16 v[76:79], v[188:191], v[92:95], v[76:79]
    s_add_u32 s4, s4, 4096
    s_addc_u32 s5, s5, 0
    global_load_dwordx4 v[176:179], v8, s[4:5] offset:0 sc1
    global_load_dwordx4 v[180:183], v9, s[4:5] offset:0 sc1
    global_load_dwordx4 v[184:187], v10, s[4:5] offset:0 sc1
    global_load_dwordx4 v[188:191], v11, s[4:5] offset:0 sc1
    s_waitcnt vmcnt(24) lgkmcnt(0)
    s_barrier
    s_add_u32 s6, s6, 1024
    s_addc_u32 s7, s7, 0
    s_add_u32 m0, s12, 24576
    s_nop 0
    global_load_lds_dwordx4 v12, s[6:7] sc1
    s_add_u32 m0, s12, 25600
    s_nop 0
    global_load_lds_dwordx4 v13, s[6:7] sc1
    ds_read_b128 v[80:83], v14 offset:32768
    ds_read_b128 v[84:87], v14 offset:33792
    ds_read_b128 v[88:91], v14 offset:34816
    ds_read_b128 v[92:95], v14 offset:35840
    v_mfma_f32_16x16x32_bf16 v[16:19], v[192:195], v[96:99], v[16:19]
    v_mfma_f32_16x16x32_bf16 v[20:23], v[192:195], v[100:103], v[20:23]
    v_mfma_f32_16x16x32_bf16 v[24:27], v[192:195], v[104:107], v[24:27]
    v_mfma_f32_16x16x32_bf16 v[28:31], v[192:195], v[108:111], v[28:31]
    v_mfma_f32_16x16x32_bf16 v[32:35], v[196:199], v[96:99], v[32:35]
    v_mfma_f32_16x16x32_bf16 v[36:39], v[196:199], v[100:103], v[36:39]
    v_mfma_f32_16x16x32_bf16 v[40:43], v[196:199], v[104:107], v[40:43]
    v_mfma_f32_16x16x32_bf16 v[44:47], v[196:199], v[108:111], v[44:47]
    v_mfma_f32_16x16x32_bf16 v[48:51], v[200:203], v[96:99], v[48:51]
    v_mfma_f32_16x16x32_bf16 v[52:55], v[200:203], v[100:103], v[52:55]
    v_mfma_f32_16x16x32_bf16 v[56:59], v[200:203], v[104:107], v[56:59]
    v_mfma_f32_16x16x32_bf16 v[60:63], v[200:203], v[108:111], v[60:63]
    v_mfma_f32_16x16x32_bf16 v[64:67], v[204:207], v[96:99], v[64:67]
    v_mfma_f32_16x16x32_bf16 v[68:71], v[204:207], v[100:103], v[68:71]
    v_mfma_f32_16x16x32_bf16 v[72:75], v[204:207], v[104:107], v[72:75]
    v_mfma_f32_16x16x32_bf16 v[76:79], v[204:207], v[108:111], v[76:79]
    global_load_dwordx4 v[192:195], v8, s[4:5] offset:1024 sc1
    global_load_dwordx4 v[196:199], v9, s[4:5] offset:1024 sc1
    global_load_dwordx4 v[200:203], v10, s[4:5] offset:1024 sc1
    global_load_dwordx4 v[204:207], v11, s[4:5] offset:1024 sc1
    s_waitcnt vmcnt(28) lgkmcnt(0)
    s_barrier
    s_add_u32 s6, s6, 1024
    s_addc_u32 s7, s7, 0
    s_add_u32 m0, s12, 32768
    s_nop 0
    global_load_lds_dwordx4 v12, s[6:7] sc1
    s_add_u32 m0, s12, 33792
    s_nop 0
    global_load_lds_dwordx4 v13, s[6:7] sc1
    ds_read_b128 v[96:99], v14 offset:40960
    ds_read_b128 v[100:103], v14 offset:41984
    ds_read_b128 v[104:107], v14 offset:43008
    ds_read_b128 v[108:111], v14 offset:44032
    v_mfma_f32_16x16x32_bf16 v[16:19], v[208:211], v[80:83], v[16:19]
    v_mfma_f32_16x16x32_bf16 v[20:23], v[208:211], v[84:87], v[20:23]
    v_mfma_f32_16x16x32_bf16 v[24:27], v[208:211], v[88:91], v[24:27]
    v_mfma_f32_16x16x32_bf16 v[28:31], v[208:211], v[92:95], v[28:31]
    v_mfma_f32_16x16x32_bf16 v[32:35], v[212:215], v[80:83], v[32:35]
    v_mfma_f32_16x16x32_bf16 v[36:39], v[212:215], v[84:87], v[36:39]
    v_mfma_f32_16x16x32_bf16 v[40:43], v[212:215], v[88:91], v[40:43]
    v_mfma_f32_16x16x32_bf16 v[44:47], v[212:215], v[92:95], v[44:47]
    v_mfma_f32_16x16x32_bf16 v[48:51], v[216:219], v[80:83], v[48:51]
    v_mfma_f32_16x16x32_bf16 v[52:55], v[216:219], v[84:87], v[52:55]
    v_mfma_f32_16x16x32_bf16 v[56:59], v[216:219], v[88:91], v[56:59]
    v_mfma_f32_16x16x32_bf16 v[60:63], v[216:219], v[92:95], v[60:63]
    v_mfma_f32_16x16x32_bf16 v[64:67], v[220:223], v[80:83], v[64:67]
    v_mfma_f32_16x16x32_bf16 v[68:71], v[220:223], v[84:87], v[68:71]
    v_mfma_f32_16x16x32_bf16 v[72:75], v[220:223], v[88:91], v[72:75]
    v_mfma_f32_16x16x32_bf16 v[76:79], v[220:223], v[92:95], v[76:79]
    global_load_dwordx4 v[208:211], v8, s[4:5] offset:2048 sc1
    global_load_dwordx4 v[212:215], v9, s[4:5] offset:2048 sc1
    global_load_dwordx4 v[216:219], v10, s[4:5] offset:2048 sc1
    global_load_dwordx4 v[220:223], v11, s[4:5] offset:2048 sc1
    s_waitcnt vmcnt(32) lgkmcnt(0)
    s_barrier
    s_add_u32 s6, s6, 1024
    s_addc_u32 s7, s7, 0
    s_add_u32 m0, s12, 40960
    s_nop 0
    global_load_lds_dwordx4 v12, s[6:7] sc1
    s_add_u32 m0, s12, 41984
    s_nop 0
    global_load_lds_dwordx4 v13, s[6:7] sc1
    ds_read_b128 v[80:83], v14 offset:49152
    ds_read_b128 v[84:87], v14 offset:50176
    ds_read_b128 v[88:91], v14 offset:51200
    ds_read_b128 v[92:95], v14 offset:52224
    v_mfma_f32_16x16x32_bf16 v[16:19], v[224:227], v[96:99], v[16:19]
    v_mfma_f32_16x16x32_bf16 v[20:23], v[224:227], v[100:103], v[20:23]
    v_mfma_f32_16x16x32_bf16 v[24:27], v[224:227], v[104:107], v[24:27]
    v_mfma_f32_16x16x32_bf16 v[28:31], v[224:227], v[108:111], v[28:31]
    v_mfma_f32_16x16x32_bf16 v[32:35], v[228:231], v[96:99], v[32:35]
    v_mfma_f32_16x16x32_bf16 v[36:39], v[228:231], v[100:103], v[36:39]
    v_mfma_f32_16x16x32_bf16 v[40:43], v[228:231], v[104:107], v[40:43]
    v_mfma_f32_16x16x32_bf16 v[44:47], v[228:231], v[108:111], v[44:47]
    v_mfma_f32_16x16x32_bf16 v[48:51], v[232:235], v[96:99], v[48:51]
    v_mfma_f32_16x16x32_bf16 v[52:55], v[232:235], v[100:103], v[52:55]
    v_mfma_f32_16x16x32_bf16 v[56:59], v[232:235], v[104:107], v[56:59]
    v_mfma_f32_16x16x32_bf16 v[60:63], v[232:235], v[108:111], v[60:63]
    v_mfma_f32_16x16x32_bf16 v[64:67], v[236:239], v[96:99], v[64:67]
    v_mfma_f32_16x16x32_bf16 v[68:71], v[236:239], v[100:103], v[68:71]
    v_mfma_f32_16x16x32_bf16 v[72:75], v[236:239], v[104:107], v[72:75]
    v_mfma_f32_16x16x32_bf16 v[76:79], v[236:239], v[108:111], v[76:79]
    global_load_dwordx4 v[224:227], v8, s[4:5] offset:3072 sc1
    global_load_dwordx4 v[228:231], v9, s[4:5] offset:3072 sc1
    global_load_dwordx4 v[232:235], v10, s[4:5] offset:3072 sc1
    global_load_dwordx4 v[236:239], v11, s[4:5] offset:3072 sc1
    s_waitcnt vmcnt(30) lgkmcnt(0)
    s_barrier
    ds_read_b128 v[96:99], v14 offset:57344
    ds_read_b128 v[100:103], v14 offset:58368
    ds_read_b128 v[104:107], v14 offset:59392
    ds_read_b128 v[108:111], v14 offset:60416
    v_mfma_f32_16x16x32_bf16 v[16:19], v[144:147], v[80:83], v[16:19]
    v_mfma_f32_16x16x32_bf16 v[20:23], v[144:147], v[84:87], v[20:23]
    v_mfma_f32_16x16x32_bf16 v[24:27], v[144:147], v[88:91], v[24:27]
    v_mfma_f32_16x16x32_bf16 v[28:31], v[144:147], v[92:95], v[28:31]
    v_mfma_f32_16x16x32_bf16 v[32:35], v[148:151], v[80:83], v[32:35]
    v_mfma_f32_16x16x32_bf16 v[36:39], v[148:151], v[84:87], v[36:39]
    v_mfma_f32_16x16x32_bf16 v[40:43], v[148:151], v[88:91], v[40:43]
    v_mfma_f32_16x16x32_bf16 v[44:47], v[148:151], v[92:95], v[44:47]
    v_mfma_f32_16x16x32_bf16 v[48:51], v[152:155], v[80:83], v[48:51]
    v_mfma_f32_16x16x32_bf16 v[52:55], v[152:155], v[84:87], v[52:55]
    v_mfma_f32_16x16x32_bf16 v[56:59], v[152:155], v[88:91], v[56:59]
    v_mfma_f32_16x16x32_bf16 v[60:63], v[152:155], v[92:95], v[60:63]
    v_mfma_f32_16x16x32_bf16 v[64:67], v[156:159], v[80:83], v[64:67]
    v_mfma_f32_16x16x32_bf16 v[68:71], v[156:159], v[84:87], v[68:71]
    v_mfma_f32_16x16x32_bf16 v[72:75], v[156:159], v[88:91], v[72:75]
    v_mfma_f32_16x16x32_bf16 v[76:79], v[156:159], v[92:95], v[76:79]
    s_add_u32 s4, s4, 4096
    s_addc_u32 s5, s5, 0
    global_load_dwordx4 v[144:147], v8, s[4:5] offset:0 sc1
    global_load_dwordx4 v[148:151], v9, s[4:5] offset:0 sc1
    global_load_dwordx4 v[152:155], v10, s[4:5] offset:0 sc1
    global_load_dwordx4 v[156:159], v11, s[4:5] offset:0 sc1
    s_waitcnt vmcnt(28) lgkmcnt(0)
    s_barrier
    ds_read_b128 v[80:83], v14 offset:0
    ds_read_b128 v[84:87], v14 offset:1024
    ds_read_b128 v[88:91], v14 offset:2048
    ds_read_b128 v[92:95], v14 offset:3072
    v_mfma_f32_16x16x32_bf16 v[16:19], v[160:163], v[96:99], v[16:19]
    v_mfma_f32_16x16x32_bf16 v[20:23], v[160:163], v[100:103], v[20:23]
    v_mfma_f32_16x16x32_bf16 v[24:27], v[160:163], v[104:107], v[24:27]
    v_mfma_f32_16x16x32_bf16 v[28:31], v[160:163], v[108:111], v[28:31]
    v_mfma_f32_16x16x32_bf16 v[32:35], v[164:167], v[96:99], v[32:35]
    v_mfma_f32_16x16x32_bf16 v[36:39], v[164:167], v[100:103], v[36:39]
    v_mfma_f32_16x16x32_bf16 v[40:43], v[164:167], v[104:107], v[40:43]
    v_mfma_f32_16x16x32_bf16 v[44:47], v[164:167], v[108:111], v[44:47]
    v_mfma_f32_16x16x32_bf16 v[48:51], v[168:171], v[96:99], v[48:51]
    v_mfma_f32_16x16x32_bf16 v[52:55], v[168:171], v[100:103], v[52:55]
    v_mfma_f32_16x16x32_bf16 v[56:59], v[168:171], v[104:107], v[56:59]
    v_mfma_f32_16x16x32_bf16 v[60:63], v[168:171], v[108:111], v[60:63]
    v_mfma_f32_16x16x32_bf16 v[64:67], v[172:175], v[96:99], v[64:67]
    v_mfma_f32_16x16x32_bf16 v[68:71], v[172:175], v[100:103], v[68:71]
    v_mfma_f32_16x16x32_bf16 v[72:75], v[172:175], v[104:107], v[72:75]
    v_mfma_f32_16x16x32_bf16 v[76:79], v[172:175], v[108:111], v[76:79]
    global_load_dwordx4 v[160:163], v8, s[4:5] offset:1024 sc1
    global_load_dwordx4 v[164:167], v9, s[4:5] offset:1024 sc1
    global_load_dwordx4 v[168:171], v10, s[4:5] offset:1024 sc1
    global_load_dwordx4 v[172:175], v11, s[4:5] offset:1024 sc1
    s_waitcnt vmcnt(26) lgkmcnt(0)
    s_barrier
    ds_read_b128 v[96:99], v14 offset:8192
    ds_read_b128 v[100:103], v14 offset:9216
    ds_read_b128 v[104:107], v14 offset:10240
    ds_read_b128 v[108:111], v14 offset:11264
    v_mfma_f32_16x16x32_bf16 v[16:19], v[176:179], v[80:83], v[16:19]
    v_mfma_f32_16x16x32_bf16 v[20:23], v[176:179], v[84:87], v[20:23]
    v_mfma_f32_16x16x32_bf16 v[24:27], v[176:179], v[88:91], v[24:27]
    v_mfma_f32_16x16x32_bf16 v[28:31], v[176:179], v[92:95], v[28:31]
    v_mfma_f32_16x16x32_bf16 v[32:35], v[180:183], v[80:83], v[32:35]
    v_mfma_f32_16x16x32_bf16 v[36:39], v[180:183], v[84:87], v[36:39]
    v_mfma_f32_16x16x32_bf16 v[40:43], v[180:183], v[88:91], v[40:43]
    v_mfma_f32_16x16x32_bf16 v[44:47], v[180:183], v[92:95], v[44:47]
    v_mfma_f32_16x16x32_bf16 v[48:51], v[184:187], v[80:83], v[48:51]
    v_mfma_f32_16x16x32_bf16 v[52:55], v[184:187], v[84:87], v[52:55]
    v_mfma_f32_16x16x32_bf16 v[56:59], v[184:187], v[88:91], v[56:59]
    v_mfma_f32_16x16x32_bf16 v[60:63], v[184:187], v[92:95], v[60:63]
    v_mfma_f32_16x16x32_bf16 v[64:67], v[188:191], v[80:83], v[64:67]
    v_mfma_f32_16x16x32_bf16 v[68:71], v[188:191], v[84:87], v[68:71]
    v_mfma_f32_16x16x32_bf16 v[72:75], v[188:191], v[88:91], v[72:75]
    v_mfma_f32_16x16x32_bf16 v[76:79], v[188:191], v[92:95], v[76:79]
    s_waitcnt vmcnt(20) lgkmcnt(0)
    s_barrier
    ds_read_b128 v[80:83], v14 offset:16384
    ds_read_b128 v[84:87], v14 offset:17408
    ds_read_b128 v[88:91], v14 offset:18432
    ds_read_b128 v[92:95], v14 offset:19456
    v_mfma_f32_16x16x32_bf16 v[16:19], v[192:195], v[96:99], v[16:19]
    v_mfma_f32_16x16x32_bf16 v[20:23], v[192:195], v[100:103], v[20:23]
    v_mfma_f32_16x16x32_bf16 v[24:27], v[192:195], v[104:107], v[24:27]
    v_mfma_f32_16x16x32_bf16 v[28:31], v[192:195], v[108:111], v[28:31]
    v_mfma_f32_16x16x32_bf16 v[32:35], v[196:199], v[96:99], v[32:35]
    v_mfma_f32_16x16x32_bf16 v[36:39], v[196:199], v[100:103], v[36:39]
    v_mfma_f32_16x16x32_bf16 v[40:43], v[196:199], v[104:107], v[40:43]
    v_mfma_f32_16x16x32_bf16 v[44:47], v[196:199], v[108:111], v[44:47]
    v_mfma_f32_16x16x32_bf16 v[48:51], v[200:203], v[96:99], v[48:51]
    v_mfma_f32_16x16x32_bf16 v[52:55], v[200:203], v[100:103], v[52:55]
    v_mfma_f32_16x16x32_bf16 v[56:59], v[200:203], v[104:107], v[56:59]
    v_mfma_f32_16x16x32_bf16 v[60:63], v[200:203], v[108:111], v[60:63]
    v_mfma_f32_16x16x32_bf16 v[64:67], v[204:207], v[96:99], v[64:67]
    v_mfma_f32_16x16x32_bf16 v[68:71], v[204:207], v[100:103], v[68:71]
    v_mfma_f32_16x16x32_bf16 v[72:75], v[204:207], v[104:107], v[72:75]
    v_mfma_f32_16x16x32_bf16 v[76:79], v[204:207], v[108:111], v[76:79]
    s_waitcnt vmcnt(14) lgkmcnt(0)
    s_barrier
    ds_read_b128 v[96:99], v14 offset:24576
    ds_read_b128 v[100:103], v14 offset:25600
    ds_read_b128 v[104:107], v14 offset:26624
    ds_read_b128 v[108:111], v14 offset:27648
    v_mfma_f32_16x16x32_bf16 v[16:19], v[208:211], v[80:83], v[16:19]
    v_mfma_f32_16x16x32_bf16 v[20:23], v[208:211], v[84:87], v[20:23]
    v_mfma_f32_16x16x32_bf16 v[24:27], v[208:211], v[88:91], v[24:27]
    v_mfma_f32_16x16x32_bf16 v[28:31], v[208:211], v[92:95], v[28:31]
    v_mfma_f32_16x16x32_bf16 v[32:35], v[212:215], v[80:83], v[32:35]
    v_mfma_f32_16x16x32_bf16 v[36:39], v[212:215], v[84:87], v[36:39]
    v_mfma_f32_16x16x32_bf16 v[40:43], v[212:215], v[88:91], v[40:43]
    v_mfma_f32_16x16x32_bf16 v[44:47], v[212:215], v[92:95], v[44:47]
    v_mfma_f32_16x16x32_bf16 v[48:51], v[216:219], v[80:83], v[48:51]
    v_mfma_f32_16x16x32_bf16 v[52:55], v[216:219], v[84:87], v[52:55]
    v_mfma_f32_16x16x32_bf16 v[56:59], v[216:219], v[88:91], v[56:59]
    v_mfma_f32_16x16x32_bf16 v[60:63], v[216:219], v[92:95], v[60:63]
    v_mfma_f32_16x16x32_bf16 v[64:67], v[220:223], v[80:83], v[64:67]
    v_mfma_f32_16x16x32_bf16 v[68:71], v[220:223], v[84:87], v[68:71]
    v_mfma_f32_16x16x32_bf16 v[72:75], v[220:223], v[88:91], v[72:75]
    v_mfma_f32_16x16x32_bf16 v[76:79], v[220:223], v[92:95], v[76:79]
    s_waitcnt vmcnt(8) lgkmcnt(0)
    s_barrier
    ds_read_b128 v[80:83], v14 offset:32768
    ds_read_b128 v[84:87], v14 offset:33792
    ds_read_b128 v[88:91], v14 offset:34816
    ds_read_b128 v[92:95], v14 offset:35840
    v_mfma_f32_16x16x32_bf16 v[16:19], v[224:227], v[96:99], v[16:19]
    v_mfma_f32_16x16x32_bf16 v[20:23], v[224:227], v[100:103], v[20:23]
    v_mfma_f32_16x16x32_bf16 v[24:27], v[224:227], v[104:107], v[24:27]
    v_mfma_f32_16x16x32_bf16 v[28:31], v[224:227], v[108:111], v[28:31]
    v_mfma_f32_16x16x32_bf16 v[32:35], v[228:231], v[96:99], v[32:35]
    v_mfma_f32_16x16x32_bf16 v[36:39], v[228:231], v[100:103], v[36:39]
    v_mfma_f32_16x16x32_bf16 v[40:43], v[228:231], v[104:107], v[40:43]
    v_mfma_f32_16x16x32_bf16 v[44:47], v[228:231], v[108:111], v[44:47]
    v_mfma_f32_16x16x32_bf16 v[48:51], v[232:235], v[96:99], v[48:51]
    v_mfma_f32_16x16x32_bf16 v[52:55], v[232:235], v[100:103], v[52:55]
    v_mfma_f32_16x16x32_bf16 v[56:59], v[232:235], v[104:107], v[56:59]
    v_mfma_f32_16x16x32_bf16 v[60:63], v[232:235], v[108:111], v[60:63]
    v_mfma_f32_16x16x32_bf16 v[64:67], v[236:239], v[96:99], v[64:67]
    v_mfma_f32_16x16x32_bf16 v[68:71], v[236:239], v[100:103], v[68:71]
    v_mfma_f32_16x16x32_bf16 v[72:75], v[236:239], v[104:107], v[72:75]
    v_mfma_f32_16x16x32_bf16 v[76:79], v[236:239], v[108:111], v[76:79]
    s_waitcnt vmcnt(4) lgkmcnt(0)
    s_barrier
    ds_read_b128 v[96:99], v14 offset:40960
    ds_read_b128 v[100:103], v14 offset:41984
    ds_read_b128 v[104:107], v14 offset:43008
    ds_read_b128 v[108:111], v14 offset:44032
    v_mfma_f32_16x16x32_bf16 v[16:19], v[144:147], v[80:83], v[16:19]
    v_mfma_f32_16x16x32_bf16 v[20:23], v[144:147], v[84:87], v[20:23]
    v_mfma_f32_16x16x32_bf16 v[24:27], v[144:147], v[88:91], v[24:27]
    v_mfma_f32_16x16x32_bf16 v[28:31], v[144:147], v[92:95], v[28:31]
    v_mfma_f32_16x16x32_bf16 v[32:35], v[148:151], v[80:83], v[32:35]
    v_mfma_f32_16x16x32_bf16 v[36:39], v[148:151], v[84:87], v[36:39]
    v_mfma_f32_16x16x32_bf16 v[40:43], v[148:151], v[88:91], v[40:43]
    v_mfma_f32_16x16x32_bf16 v[44:47], v[148:151], v[92:95], v[44:47]
    v_mfma_f32_16x16x32_bf16 v[48:51], v[152:155], v[80:83], v[48:51]
    v_mfma_f32_16x16x32_bf16 v[52:55], v[152:155], v[84:87], v[52:55]
    v_mfma_f32_16x16x32_bf16 v[56:59], v[152:155], v[88:91], v[56:59]
    v_mfma_f32_16x16x32_bf16 v[60:63], v[152:155], v[92:95], v[60:63]
    v_mfma_f32_16x16x32_bf16 v[64:67], v[156:159], v[80:83], v[64:67]
    v_mfma_f32_16x16x32_bf16 v[68:71], v[156:159], v[84:87], v[68:71]
    v_mfma_f32_16x16x32_bf16 v[72:75], v[156:159], v[88:91], v[72:75]
    v_mfma_f32_16x16x32_bf16 v[76:79], v[156:159], v[92:95], v[76:79]
    s_waitcnt vmcnt(0) lgkmcnt(0)
    v_mfma_f32_16x16x32_bf16 v[16:19], v[160:163], v[96:99], v[16:19]
    v_mfma_f32_16x16x32_bf16 v[20:23], v[160:163], v[100:103], v[20:23]
    v_mfma_f32_16x16x32_bf16 v[24:27], v[160:163], v[104:107], v[24:27]
    v_mfma_f32_16x16x32_bf16 v[28:31], v[160:163], v[108:111], v[28:31]
    v_mfma_f32_16x16x32_bf16 v[32:35], v[164:167], v[96:99], v[32:35]
    v_mfma_f32_16x16x32_bf16 v[36:39], v[164:167], v[100:103], v[36:39]
    v_mfma_f32_16x16x32_bf16 v[40:43], v[164:167], v[104:107], v[40:43]
    v_mfma_f32_16x16x32_bf16 v[44:47], v[164:167], v[108:111], v[44:47]
    v_mfma_f32_16x16x32_bf16 v[48:51], v[168:171], v[96:99], v[48:51]
    v_mfma_f32_16x16x32_bf16 v[52:55], v[168:171], v[100:103], v[52:55]
    v_mfma_f32_16x16x32_bf16 v[56:59], v[168:171], v[104:107], v[56:59]
    v_mfma_f32_16x16x32_bf16 v[60:63], v[168:171], v[108:111], v[60:63]
    v_mfma_f32_16x16x32_bf16 v[64:67], v[172:175], v[96:99], v[64:67]
    v_mfma_f32_16x16x32_bf16 v[68:71], v[172:175], v[100:103], v[68:71]
    v_mfma_f32_16x16x32_bf16 v[72:75], v[172:175], v[104:107], v[72:75]
    v_mfma_f32_16x16x32_bf16 v[76:79], v[172:175], v[108:111], v[76:79]
    s_add_u32 s4, s64, 16777216
    s_addc_u32 s5, s65, 0
    v_mul_u32_u24 v6, 3584, v5
    v_lshl_add_u32 v6, v4, 5, v6
    v_lshrrev_b32 v7, 1, v2
    v_lshl_add_u32 v6, v7, 10, v6
    v_and_b32 v7, 1, v2
    v_lshl_add_u32 v6, v7, 9, v6
    v_lshl_add_u32 v6, v1, 4, v6
    s_nop 4
    v_max_f32 v16, 0, v16
    v_max_f32 v17, 0, v17
    v_max_f32 v18, 0, v18
    v_max_f32 v19, 0, v19
    v_cvt_pk_bf16_f32 v80, v16, v17
    v_cvt_pk_bf16_f32 v81, v18, v19
    v_max_f32 v32, 0, v32
    v_max_f32 v33, 0, v33
    v_max_f32 v34, 0, v34
    v_max_f32 v35, 0, v35
    v_cvt_pk_bf16_f32 v82, v32, v33
    v_cvt_pk_bf16_f32 v83, v34, v35
    v_max_f32 v48, 0, v48
    v_max_f32 v49, 0, v49
    v_max_f32 v50, 0, v50
    v_max_f32 v51, 0, v51
    v_cvt_pk_bf16_f32 v84, v48, v49
    v_cvt_pk_bf16_f32 v85, v50, v51
    v_max_f32 v64, 0, v64
    v_max_f32 v65, 0, v65
    v_max_f32 v66, 0, v66
    v_max_f32 v67, 0, v67
    v_cvt_pk_bf16_f32 v86, v64, v65
    v_cvt_pk_bf16_f32 v87, v66, v67
    global_store_dwordx4 v6, v[80:83], s[4:5] sc1
    global_store_dwordx4 v6, v[84:87], s[4:5] offset:256 sc1
    v_max_f32 v20, 0, v20
    v_max_f32 v21, 0, v21
    v_max_f32 v22, 0, v22
    v_max_f32 v23, 0, v23
    v_cvt_pk_bf16_f32 v88, v20, v21
    v_cvt_pk_bf16_f32 v89, v22, v23
    v_max_f32 v36, 0, v36
    v_max_f32 v37, 0, v37
    v_max_f32 v38, 0, v38
    v_max_f32 v39, 0, v39
    v_cvt_pk_bf16_f32 v90, v36, v37
    v_cvt_pk_bf16_f32 v91, v38, v39
    v_max_f32 v52, 0, v52
    v_max_f32 v53, 0, v53
    v_max_f32 v54, 0, v54
    v_max_f32 v55, 0, v55
    v_cvt_pk_bf16_f32 v92, v52, v53
    v_cvt_pk_bf16_f32 v93, v54, v55
    v_max_f32 v68, 0, v68
    v_max_f32 v69, 0, v69
    v_max_f32 v70, 0, v70
    v_max_f32 v71, 0, v71
    v_cvt_pk_bf16_f32 v94, v68, v69
    v_cvt_pk_bf16_f32 v95, v70, v71
    v_add_u32 v6, 57344, v6
    global_store_dwordx4 v6, v[88:91], s[4:5] sc1
    global_store_dwordx4 v6, v[92:95], s[4:5] offset:256 sc1
    v_max_f32 v24, 0, v24
    v_max_f32 v25, 0, v25
    v_max_f32 v26, 0, v26
    v_max_f32 v27, 0, v27
    v_cvt_pk_bf16_f32 v96, v24, v25
    v_cvt_pk_bf16_f32 v97, v26, v27
    v_max_f32 v40, 0, v40
    v_max_f32 v41, 0, v41
    v_max_f32 v42, 0, v42
    v_max_f32 v43, 0, v43
    v_cvt_pk_bf16_f32 v98, v40, v41
    v_cvt_pk_bf16_f32 v99, v42, v43
    v_max_f32 v56, 0, v56
    v_max_f32 v57, 0, v57
    v_max_f32 v58, 0, v58
    v_max_f32 v59, 0, v59
    v_cvt_pk_bf16_f32 v100, v56, v57
    v_cvt_pk_bf16_f32 v101, v58, v59
    v_max_f32 v72, 0, v72
    v_max_f32 v73, 0, v73
    v_max_f32 v74, 0, v74
    v_max_f32 v75, 0, v75
    v_cvt_pk_bf16_f32 v102, v72, v73
    v_cvt_pk_bf16_f32 v103, v74, v75
    v_add_u32 v6, 57344, v6
    global_store_dwordx4 v6, v[96:99], s[4:5] sc1
    global_store_dwordx4 v6, v[100:103], s[4:5] offset:256 sc1
    v_max_f32 v28, 0, v28
    v_max_f32 v29, 0, v29
    v_max_f32 v30, 0, v30
    v_max_f32 v31, 0, v31
    v_cvt_pk_bf16_f32 v104, v28, v29
    v_cvt_pk_bf16_f32 v105, v30, v31
    v_max_f32 v44, 0, v44
    v_max_f32 v45, 0, v45
    v_max_f32 v46, 0, v46
    v_max_f32 v47, 0, v47
    v_cvt_pk_bf16_f32 v106, v44, v45
    v_cvt_pk_bf16_f32 v107, v46, v47
    v_max_f32 v60, 0, v60
    v_max_f32 v61, 0, v61
    v_max_f32 v62, 0, v62
    v_max_f32 v63, 0, v63
    v_cvt_pk_bf16_f32 v108, v60, v61
    v_cvt_pk_bf16_f32 v109, v62, v63
    v_max_f32 v76, 0, v76
    v_max_f32 v77, 0, v77
    v_max_f32 v78, 0, v78
    v_max_f32 v79, 0, v79
    v_cvt_pk_bf16_f32 v110, v76, v77
    v_cvt_pk_bf16_f32 v111, v78, v79
    v_add_u32 v6, 57344, v6
    global_store_dwordx4 v6, v[104:107], s[4:5] sc1
    global_store_dwordx4 v6, v[108:111], s[4:5] offset:256 sc1
    s_waitcnt vmcnt(0) lgkmcnt(0)
    s_barrier
    s_cmp_lg_u32 s69, 0
    s_cbranch_scc1 PB_end_20
    s_cmp_lg_u32 s68, 0
    s_cbranch_scc1 N_ok_22
    s_waitcnt vmcnt(0)
    v_readfirstlane_b32 s68, v255
    s_cmp_lg_u32 s68, 0
    s_cbranch_scc1 N_ok_22
    v_mov_b32 v253, 0
N_poll_21:
    global_load_dword v254, v253, s[66:67] sc1
    s_waitcnt vmcnt(0)
    v_readfirstlane_b32 s68, v254
    s_cmp_lg_u32 s68, 0
    s_cbranch_scc1 N_ok_22
    s_sleep 4
    s_branch N_poll_21
N_ok_22:
    v_mov_b32 v254, s68
    s_mov_b64 s[72:73], exec
    s_mov_b64 exec, 1
    v_mov_b32 v253, s74
    global_store_dword v253, v254, s[70:71] sc1
    s_mov_b64 exec, s[72:73]
PB_end_20:
    s_setprio 0
    s_load_dwordx2 s[16:17], s[0:1], 0
    s_load_dwordx2 s[18:19], s[0:1], 48
    s_load_dwordx2 s[20:21], s[0:1], 80
    s_mov_b32 s14, s64
    s_mov_b32 s15, s65
    v_and_b32 v4, 63, v0
    s_and_b32 s10, s2, 7
    s_lshr_b32 s3, s2, 3
    s_mul_i32 s8, s3, 9363
    s_lshr_b32 s8, s8, 16
    s_mul_i32 s9, s8, 7
    s_sub_u32 s9, s3, s9
    s_lshl_b32 s10, s10, 2
    s_add_u32 s8, s8, s10
    s_lshr_b32 s76, s8, 1
    s_lshl_b32 s76, s76, 6
    s_add_u32 s76, s76, 3072
    s_lshl_b32 s77, s9, 7
    s_add_u32 s78, s77, 4096
    s_add_u32 s77, s77, 2048
    s_lshl_b32 s9, s9, 6
    s_lshl_b32 s8, s8, 6
    s_cmp_lg_u32 s69, 0
    s_cbranch_scc1 W_end_23
    s_cmp_lg_u32 s68, 0
    s_cbranch_scc1 N_ok_25
    s_waitcnt vmcnt(0)
    v_readfirstlane_b32 s68, v255
    s_cmp_lg_u32 s68, 0
    s_cbranch_scc1 N_ok_25
    v_mov_b32 v253, 0
N_poll_24:
    global_load_dword v254, v253, s[66:67] sc1
    s_waitcnt vmcnt(0)
    v_readfirstlane_b32 s68, v254
    s_cmp_lg_u32 s68, 0
    s_cbranch_scc1 N_ok_25
    s_sleep 4
    s_branch N_poll_24
N_ok_25:
    v_and_b32 v253, 63, v0
    v_min_u32 v253, 27, v253
    v_lshl_add_u32 v253, v253, 2, s77
W_poll_26:
    global_load_dword v254, v253, s[70:71] sc1
    s_waitcnt vmcnt(0)
    v_cmp_ne_u32 vcc, s68, v254
    s_cmp_eq_u64 vcc, 0
    s_cbranch_scc1 W_ok_27
    s_sleep 3
    s_branch W_poll_26
W_ok_27:
    v_and_b32 v253, 63, v0
    v_min_u32 v253, 13, v253
    v_lshl_add_u32 v253, v253, 2, s76
W_poll_28:
    global_load_dword v254, v253, s[70:71] sc1
    s_waitcnt vmcnt(0)
    v_cmp_ne_u32 vcc, s68, v254
    s_cmp_eq_u64 vcc, 0
    s_cbranch_scc1 W_ok_29
    s_sleep 3
    s_branch W_poll_28
W_ok_29:
W_end_23:
    s_barrier
    s_waitcnt lgkmcnt(0)
    s_add_u32 s4, s64, 6291456
    s_addc_u32 s5, s65, 0
    s_add_u32 s6, s64, 16777216
    s_addc_u32 s7, s65, 0
    s_add_u32 s10, s64, 25165824
    s_addc_u32 s11, s65, 0
    v_mul_u32_u24 v7, 14336, v3
    v_lshl_add_u32 v7, v4, 4, v7
    s_mul_i32 s12, s9, 3584
    v_add_u32 v8, s12, v7
    v_add_u32 v9, 57344, v8
    v_add_u32 v10, 114688, v8
    v_add_u32 v11, 172032, v8
    s_mul_i32 s12, s8, 3584
    v_add_u32 v12, s12, v7
    v_add_u32 v13, 57344, v12
    v_add_u32 v14, 114688, v12
    v_add_u32 v15, 172032, v12
    global_load_dwordx4 v[80:83], v8, s[4:5] offset:0 sc1
    global_load_dwordx4 v[84:87], v9, s[4:5] offset:0 sc1
    global_load_dwordx4 v[88:91], v10, s[4:5] offset:0 sc1
    global_load_dwordx4 v[92:95], v11, s[4:5] offset:0 sc1
    global_load_dwordx4 v[96:99], v12, s[6:7] offset:0 sc1
    global_load_dwordx4 v[100:103], v13, s[6:7] offset:0 sc1
    global_load_dwordx4 v[104:107], v14, s[6:7] offset:0 sc1
    global_load_dwordx4 v[108:111], v15, s[6:7] offset:0 sc1
    global_load_dwordx4 v[112:115], v8, s[4:5] offset:1024 sc1
    global_load_dwordx4 v[116:119], v9, s[4:5] offset:1024 sc1
    global_load_dwordx4 v[120:123], v10, s[4:5] offset:1024 sc1
    global_load_dwordx4 v[124:127], v11, s[4:5] offset:1024 sc1
    global_load_dwordx4 v[128:131], v12, s[6:7] offset:1024 sc1
    global_load_dwordx4 v[132:135], v13, s[6:7] offset:1024 sc1
    global_load_dwordx4 v[136:139], v14, s[6:7] offset:1024 sc1
    global_load_dwordx4 v[140:143], v15, s[6:7] offset:1024 sc1
    global_load_dwordx4 v[144:147], v8, s[4:5] offset:2048 sc1
    global_load_dwordx4 v[148:151], v9, s[4:5] offset:2048 sc1
    global_load_dwordx4 v[152:155], v10, s[4:5] offset:2048 sc1
    global_load_dwordx4 v[156:159], v11, s[4:5] offset:2048 sc1
    global_load_dwordx4 v[160:163], v12, s[6:7] offset:2048 sc1
    global_load_dwordx4 v[164:167], v13, s[6:7] offset:2048 sc1
    global_load_dwordx4 v[168:171], v14, s[6:7] offset:2048 sc1
    global_load_dwordx4 v[172:175], v15, s[6:7] offset:2048 sc1
    global_load_dwordx4 v[176:179], v8, s[4:5] offset:3072 sc1
    global_load_dwordx4 v[180:183], v9, s[4:5] offset:3072 sc1
    global_load_dwordx4 v[184:187], v10, s[4:5] offset:3072 sc1
    global_load_dwordx4 v[188:191], v11, s[4:5] offset:3072 sc1
    global_load_dwordx4 v[192:195], v12, s[6:7] offset:3072 sc1
    global_load_dwordx4 v[196:199], v13, s[6:7] offset:3072 sc1
    global_load_dwordx4 v[200:203], v14, s[6:7] offset:3072 sc1
    global_load_dwordx4 v[204:207], v15, s[6:7] offset:3072 sc1
    s_waitcnt vmcnt(24)
    v_mfma_f32_16x16x32_bf16 v[16:19], v[80:83], v[96:99], 0
    v_mfma_f32_16x16x32_bf16 v[20:23], v[80:83], v[100:103], 0
    v_mfma_f32_16x16x32_bf16 v[24:27], v[80:83], v[104:107], 0
    v_mfma_f32_16x16x32_bf16 v[28:31], v[80:83], v[108:111], 0
    v_mfma_f32_16x16x32_bf16 v[32:35], v[84:87], v[96:99], 0
    v_mfma_f32_16x16x32_bf16 v[36:39], v[84:87], v[100:103], 0
    v_mfma_f32_16x16x32_bf16 v[40:43], v[84:87], v[104:107], 0
    v_mfma_f32_16x16x32_bf16 v[44:47], v[84:87], v[108:111], 0
    v_mfma_f32_16x16x32_bf16 v[48:51], v[88:91], v[96:99], 0
    v_mfma_f32_16x16x32_bf16 v[52:55], v[88:91], v[100:103], 0
    v_mfma_f32_16x16x32_bf16 v[56:59], v[88:91], v[104:107], 0
    v_mfma_f32_16x16x32_bf16 v[60:63], v[88:91], v[108:111], 0
    v_mfma_f32_16x16x32_bf16 v[64:67], v[92:95], v[96:99], 0
    v_mfma_f32_16x16x32_bf16 v[68:71], v[92:95], v[100:103], 0
    v_mfma_f32_16x16x32_bf16 v[72:75], v[92:95], v[104:107], 0
    v_mfma_f32_16x16x32_bf16 v[76:79], v[92:95], v[108:111], 0
    s_add_u32 s4, s4, 4096
    s_addc_u32 s5, s5, 0
    s_add_u32 s6, s6, 4096
    s_addc_u32 s7, s7, 0
    global_load_dwordx4 v[80:83], v8, s[4:5] offset:0 sc1
    global_load_dwordx4 v[84:87], v9, s[4:5] offset:0 sc1
    global_load_dwordx4 v[88:91], v10, s[4:5] offset:0 sc1
    global_load_dwordx4 v[92:95], v11, s[4:5] offset:0 sc1
    global_load_dwordx4 v[96:99], v12, s[6:7] offset:0 sc1
    global_load_dwordx4 v[100:103], v13, s[6:7] offset:0 sc1
    global_load_dwordx4 v[104:107], v14, s[6:7] offset:0 sc1
    global_load_dwordx4 v[108:111], v15, s[6:7] offset:0 sc1
    s_waitcnt vmcnt(24)
    v_mfma_f32_16x16x32_bf16 v[16:19], v[112:115], v[128:131], v[16:19]
    v_mfma_f32_16x16x32_bf16 v[20:23], v[112:115], v[132:135], v[20:23]
    v_mfma_f32_16x16x32_bf16 v[24:27], v[112:115], v[136:139], v[24:27]
    v_mfma_f32_16x16x32_bf16 v[28:31], v[112:115], v[140:143], v[28:31]
    v_mfma_f32_16x16x32_bf16 v[32:35], v[116:119], v[128:131], v[32:35]
    v_mfma_f32_16x16x32_bf16 v[36:39], v[116:119], v[132:135], v[36:39]
    v_mfma_f32_16x16x32_bf16 v[40:43], v[116:119], v[136:139], v[40:43]
    v_mfma_f32_16x16x32_bf16 v[44:47], v[116:119], v[140:143], v[44:47]
    v_mfma_f32_16x16x32_bf16 v[48:51], v[120:123], v[128:131], v[48:51]
    v_mfma_f32_16x16x32_bf16 v[52:55], v[120:123], v[132:135], v[52:55]
    v_mfma_f32_16x16x32_bf16 v[56:59], v[120:123], v[136:139], v[56:59]
    v_mfma_f32_16x16x32_bf16 v[60:63], v[120:123], v[140:143], v[60:63]
    v_mfma_f32_16x16x32_bf16 v[64:67], v[124:127], v[128:131], v[64:67]
    v_mfma_f32_16x16x32_bf16 v[68:71], v[124:127], v[132:135], v[68:71]
    v_mfma_f32_16x16x32_bf16 v[72:75], v[124:127], v[136:139], v[72:75]
    v_mfma_f32_16x16x32_bf16 v[76:79], v[124:127], v[140:143], v[76:79]
    global_load_dwordx4 v[112:115], v8, s[4:5] offset:1024 sc1
    global_load_dwordx4 v[116:119], v9, s[4:5] offset:1024 sc1
    global_load_dwordx4 v[120:123], v10, s[4:5] offset:1024 sc1
    global_load_dwordx4 v[124:127], v11, s[4:5] offset:1024 sc1
    global_load_dwordx4 v[128:131], v12, s[6:7] offset:1024 sc1
    global_load_dwordx4 v[132:135], v13, s[6:7] offset:1024 sc1
    global_load_dwordx4 v[136:139], v14, s[6:7] offset:1024 sc1
    global_load_dwordx4 v[140:143], v15, s[6:7] offset:1024 sc1
    s_waitcnt vmcnt(24)
    v_mfma_f32_16x16x32_bf16 v[16:19], v[144:147], v[160:163], v[16:19]
    v_mfma_f32_16x16x32_bf16 v[20:23], v[144:147], v[164:167], v[20:23]
    v_mfma_f32_16x16x32_bf16 v[24:27], v[144:147], v[168:171], v[24:27]
    v_mfma_f32_16x16x32_bf16 v[28:31], v[144:147], v[172:175], v[28:31]
    v_mfma_f32_16x16x32_bf16 v[32:35], v[148:151], v[160:163], v[32:35]
    v_mfma_f32_16x16x32_bf16 v[36:39], v[148:151], v[164:167], v[36:39]
    v_mfma_f32_16x16x32_bf16 v[40:43], v[148:151], v[168:171], v[40:43]
    v_mfma_f32_16x16x32_bf16 v[44:47], v[148:151], v[172:175], v[44:47]
    v_mfma_f32_16x16x32_bf16 v[48:51], v[152:155], v[160:163], v[48:51]
    v_mfma_f32_16x16x32_bf16 v[52:55], v[152:155], v[164:167], v[52:55]
    v_mfma_f32_16x16x32_bf16 v[56:59], v[152:155], v[168:171], v[56:59]
    v_mfma_f32_16x16x32_bf16 v[60:63], v[152:155], v[172:175], v[60:63]
    v_mfma_f32_16x16x32_bf16 v[64:67], v[156:159], v[160:163], v[64:67]
    v_mfma_f32_16x16x32_bf16 v[68:71], v[156:159], v[164:167], v[68:71]
    v_mfma_f32_16x16x32_bf16 v[72:75], v[156:159], v[168:171], v[72:75]
    v_mfma_f32_16x16x32_bf16 v[76:79], v[156:159], v[172:175], v[76:79]
    global_load_dwordx4 v[144:147], v8, s[4:5] offset:2048 sc1
    global_load_dwordx4 v[148:151], v9, s[4:5] offset:2048 sc1
    global_load_dwordx4 v[152:155], v10, s[4:5] offset:2048 sc1
    global_load_dwordx4 v[156:159], v11, s[4:5] offset:2048 sc1
    global_load_dwordx4 v[160:163], v12, s[6:7] offset:2048 sc1
    global_load_dwordx4 v[164:167], v13, s[6:7] offset:2048 sc1
    global_load_dwordx4 v[168:171], v14, s[6:7] offset:2048 sc1
    global_load_dwordx4 v[172:175], v15, s[6:7] offset:2048 sc1
    s_waitcnt vmcnt(24)
    v_mfma_f32_16x16x32_bf16 v[16:19], v[176:179], v[192:195], v[16:19]
    v_mfma_f32_16x16x32_bf16 v[20:23], v[176:179], v[196:199], v[20:23]
    v_mfma_f32_16x16x32_bf16 v[24:27], v[176:179], v[200:203], v[24:27]
    v_mfma_f32_16x16x32_bf16 v[28:31], v[176:179], v[204:207], v[28:31]
    v_mfma_f32_16x16x32_bf16 v[32:35], v[180:183], v[192:195], v[32:35]
    v_mfma_f32_16x16x32_bf16 v[36:39], v[180:183], v[196:199], v[36:39]
    v_mfma_f32_16x16x32_bf16 v[40:43], v[180:183], v[200:203], v[40:43]
    v_mfma_f32_16x16x32_bf16 v[44:47], v[180:183], v[204:207], v[44:47]
    v_mfma_f32_16x16x32_bf16 v[48:51], v[184:187], v[192:195], v[48:51]
    v_mfma_f32_16x16x32_bf16 v[52:55], v[184:187], v[196:199], v[52:55]
    v_mfma_f32_16x16x32_bf16 v[56:59], v[184:187], v[200:203], v[56:59]
    v_mfma_f32_16x16x32_bf16 v[60:63], v[184:187], v[204:207], v[60:63]
    v_mfma_f32_16x16x32_bf16 v[64:67], v[188:191], v[192:195], v[64:67]
    v_mfma_f32_16x16x32_bf16 v[68:71], v[188:191], v[196:199], v[68:71]
    v_mfma_f32_16x16x32_bf16 v[72:75], v[188:191], v[200:203], v[72:75]
    v_mfma_f32_16x16x32_bf16 v[76:79], v[188:191], v[204:207], v[76:79]
    global_load_dwordx4 v[176:179], v8, s[4:5] offset:3072 sc1
    global_load_dwordx4 v[180:183], v9, s[4:5] offset:3072 sc1
    global_load_dwordx4 v[184:187], v10, s[4:5] offset:3072 sc1
    global_load_dwordx4 v[188:191], v11, s[4:5] offset:3072 sc1
    global_load_dwordx4 v[192:195], v12, s[6:7] offset:3072 sc1
    global_load_dwordx4 v[196:199], v13, s[6:7] offset:3072 sc1
    global_load_dwordx4 v[200:203], v14, s[6:7] offset:3072 sc1
    global_load_dwordx4 v[204:207], v15, s[6:7] offset:3072 sc1
    s_waitcnt vmcnt(24)
    v_mfma_f32_16x16x32_bf16 v[16:19], v[80:83], v[96:99], v[16:19]
    v_mfma_f32_16x16x32_bf16 v[20:23], v[80:83], v[100:103], v[20:23]
    v_mfma_f32_16x16x32_bf16 v[24:27], v[80:83], v[104:107], v[24:27]
    v_mfma_f32_16x16x32_bf16 v[28:31], v[80:83], v[108:111], v[28:31]
    v_mfma_f32_16x16x32_bf16 v[32:35], v[84:87], v[96:99], v[32:35]
    v_mfma_f32_16x16x32_bf16 v[36:39], v[84:87], v[100:103], v[36:39]
    v_mfma_f32_16x16x32_bf16 v[40:43], v[84:87], v[104:107], v[40:43]
    v_mfma_f32_16x16x32_bf16 v[44:47], v[84:87], v[108:111], v[44:47]
    v_mfma_f32_16x16x32_bf16 v[48:51], v[88:91], v[96:99], v[48:51]
    v_mfma_f32_16x16x32_bf16 v[52:55], v[88:91], v[100:103], v[52:55]
    v_mfma_f32_16x16x32_bf16 v[56:59], v[88:91], v[104:107], v[56:59]
    v_mfma_f32_16x16x32_bf16 v[60:63], v[88:91], v[108:111], v[60:63]
    v_mfma_f32_16x16x32_bf16 v[64:67], v[92:95], v[96:99], v[64:67]
    v_mfma_f32_16x16x32_bf16 v[68:71], v[92:95], v[100:103], v[68:71]
    v_mfma_f32_16x16x32_bf16 v[72:75], v[92:95], v[104:107], v[72:75]
    v_mfma_f32_16x16x32_bf16 v[76:79], v[92:95], v[108:111], v[76:79]
    s_add_u32 s4, s4, 4096
    s_addc_u32 s5, s5, 0
    s_add_u32 s6, s6, 4096
    s_addc_u32 s7, s7, 0
    global_load_dwordx4 v[80:83], v8, s[4:5] offset:0 sc1
    global_load_dwordx4 v[84:87], v9, s[4:5] offset:0 sc1
    global_load_dwordx4 v[88:91], v10, s[4:5] offset:0 sc1
    global_load_dwordx4 v[92:95], v11, s[4:5] offset:0 sc1
    global_load_dwordx4 v[96:99], v12, s[6:7] offset:0 sc1
    global_load_dwordx4 v[100:103], v13, s[6:7] offset:0 sc1
    global_load_dwordx4 v[104:107], v14, s[6:7] offset:0 sc1
    global_load_dwordx4 v[108:111], v15, s[6:7] offset:0 sc1
    s_waitcnt vmcnt(24)
    v_mfma_f32_16x16x32_bf16 v[16:19], v[112:115], v[128:131], v[16:19]
    v_mfma_f32_16x16x32_bf16 v[20:23], v[112:115], v[132:135], v[20:23]
    v_mfma_f32_16x16x32_bf16 v[24:27], v[112:115], v[136:139], v[24:27]
    v_mfma_f32_16x16x32_bf16 v[28:31], v[112:115], v[140:143], v[28:31]
    v_mfma_f32_16x16x32_bf16 v[32:35], v[116:119], v[128:131], v[32:35]
    v_mfma_f32_16x16x32_bf16 v[36:39], v[116:119], v[132:135], v[36:39]
    v_mfma_f32_16x16x32_bf16 v[40:43], v[116:119], v[136:139], v[40:43]
    v_mfma_f32_16x16x32_bf16 v[44:47], v[116:119], v[140:143], v[44:47]
    v_mfma_f32_16x16x32_bf16 v[48:51], v[120:123], v[128:131], v[48:51]
    v_mfma_f32_16x16x32_bf16 v[52:55], v[120:123], v[132:135], v[52:55]
    v_mfma_f32_16x16x32_bf16 v[56:59], v[120:123], v[136:139], v[56:59]
    v_mfma_f32_16x16x32_bf16 v[60:63], v[120:123], v[140:143], v[60:63]
    v_mfma_f32_16x16x32_bf16 v[64:67], v[124:127], v[128:131], v[64:67]
    v_mfma_f32_16x16x32_bf16 v[68:71], v[124:127], v[132:135], v[68:71]
    v_mfma_f32_16x16x32_bf16 v[72:75], v[124:127], v[136:139], v[72:75]
    v_mfma_f32_16x16x32_bf16 v[76:79], v[124:127], v[140:143], v[76:79]
    global_load_dwordx4 v[112:115], v8, s[4:5] offset:1024 sc1
    global_load_dwordx4 v[116:119], v9, s[4:5] offset:1024 sc1
    global_load_dwordx4 v[120:123], v10, s[4:5] offset:1024 sc1
    global_load_dwordx4 v[124:127], v11, s[4:5] offset:1024 sc1
    global_load_dwordx4 v[128:131], v12, s[6:7] offset:1024 sc1
    global_load_dwordx4 v[132:135], v13, s[6:7] offset:1024 sc1
    global_load_dwordx4 v[136:139], v14, s[6:7] offset:1024 sc1
    global_load_dwordx4 v[140:143], v15, s[6:7] offset:1024 sc1
    s_waitcnt vmcnt(24)
    v_mfma_f32_16x16x32_bf16 v[16:19], v[144:147], v[160:163], v[16:19]
    v_mfma_f32_16x16x32_bf16 v[20:23], v[144:147], v[164:167], v[20:23]
    v_mfma_f32_16x16x32_bf16 v[24:27], v[144:147], v[168:171], v[24:27]
    v_mfma_f32_16x16x32_bf16 v[28:31], v[144:147], v[172:175], v[28:31]
    v_mfma_f32_16x16x32_bf16 v[32:35], v[148:151], v[160:163], v[32:35]
    v_mfma_f32_16x16x32_bf16 v[36:39], v[148:151], v[164:167], v[36:39]
    v_mfma_f32_16x16x32_bf16 v[40:43], v[148:151], v[168:171], v[40:43]
    v_mfma_f32_16x16x32_bf16 v[44:47], v[148:151], v[172:175], v[44:47]
    v_mfma_f32_16x16x32_bf16 v[48:51], v[152:155], v[160:163], v[48:51]
    v_mfma_f32_16x16x32_bf16 v[52:55], v[152:155], v[164:167], v[52:55]
    v_mfma_f32_16x16x32_bf16 v[56:59], v[152:155], v[168:171], v[56:59]
    v_mfma_f32_16x16x32_bf16 v[60:63], v[152:155], v[172:175], v[60:63]
    v_mfma_f32_16x16x32_bf16 v[64:67], v[156:159], v[160:163], v[64:67]
    v_mfma_f32_16x16x32_bf16 v[68:71], v[156:159], v[164:167], v[68:71]
    v_mfma_f32_16x16x32_bf16 v[72:75], v[156:159], v[168:171], v[72:75]
    v_mfma_f32_16x16x32_bf16 v[76:79], v[156:159], v[172:175], v[76:79]
    global_load_dwordx4 v[144:147], v8, s[4:5] offset:2048 sc1
    global_load_dwordx4 v[148:151], v9, s[4:5] offset:2048 sc1
    global_load_dwordx4 v[152:155], v10, s[4:5] offset:2048 sc1
    global_load_dwordx4 v[156:159], v11, s[4:5] offset:2048 sc1
    global_load_dwordx4 v[160:163], v12, s[6:7] offset:2048 sc1
    global_load_dwordx4 v[164:167], v13, s[6:7] offset:2048 sc1
    global_load_dwordx4 v[168:171], v14, s[6:7] offset:2048 sc1
    global_load_dwordx4 v[172:175], v15, s[6:7] offset:2048 sc1
    s_waitcnt vmcnt(24)
    v_mfma_f32_16x16x32_bf16 v[16:19], v[176:179], v[192:195], v[16:19]
    v_mfma_f32_16x16x32_bf16 v[20:23], v[176:179], v[196:199], v[20:23]
    v_mfma_f32_16x16x32_bf16 v[24:27], v[176:179], v[200:203], v[24:27]
    v_mfma_f32_16x16x32_bf16 v[28:31], v[176:179], v[204:207], v[28:31]
    v_mfma_f32_16x16x32_bf16 v[32:35], v[180:183], v[192:195], v[32:35]
    v_mfma_f32_16x16x32_bf16 v[36:39], v[180:183], v[196:199], v[36:39]
    v_mfma_f32_16x16x32_bf16 v[40:43], v[180:183], v[200:203], v[40:43]
    v_mfma_f32_16x16x32_bf16 v[44:47], v[180:183], v[204:207], v[44:47]
    v_mfma_f32_16x16x32_bf16 v[48:51], v[184:187], v[192:195], v[48:51]
    v_mfma_f32_16x16x32_bf16 v[52:55], v[184:187], v[196:199], v[52:55]
    v_mfma_f32_16x16x32_bf16 v[56:59], v[184:187], v[200:203], v[56:59]
    v_mfma_f32_16x16x32_bf16 v[60:63], v[184:187], v[204:207], v[60:63]
    v_mfma_f32_16x16x32_bf16 v[64:67], v[188:191], v[192:195], v[64:67]
    v_mfma_f32_16x16x32_bf16 v[68:71], v[188:191], v[196:199], v[68:71]
    v_mfma_f32_16x16x32_bf16 v[72:75], v[188:191], v[200:203], v[72:75]
    v_mfma_f32_16x16x32_bf16 v[76:79], v[188:191], v[204:207], v[76:79]
    global_load_dwordx4 v[176:179], v8, s[4:5] offset:3072 sc1
    global_load_dwordx4 v[180:183], v9, s[4:5] offset:3072 sc1
    global_load_dwordx4 v[184:187], v10, s[4:5] offset:3072 sc1
    global_load_dwordx4 v[188:191], v11, s[4:5] offset:3072 sc1
    global_load_dwordx4 v[192:195], v12, s[6:7] offset:3072 sc1
    global_load_dwordx4 v[196:199], v13, s[6:7] offset:3072 sc1
    global_load_dwordx4 v[200:203], v14, s[6:7] offset:3072 sc1
    global_load_dwordx4 v[204:207], v15, s[6:7] offset:3072 sc1
    s_waitcnt vmcnt(24)
    v_mfma_f32_16x16x32_bf16 v[16:19], v[80:83], v[96:99], v[16:19]
    v_mfma_f32_16x16x32_bf16 v[20:23], v[80:83], v[100:103], v[20:23]
    v_mfma_f32_16x16x32_bf16 v[24:27], v[80:83], v[104:107], v[24:27]
    v_mfma_f32_16x16x32_bf16 v[28:31], v[80:83], v[108:111], v[28:31]
    v_mfma_f32_16x16x32_bf16 v[32:35], v[84:87], v[96:99], v[32:35]
    v_mfma_f32_16x16x32_bf16 v[36:39], v[84:87], v[100:103], v[36:39]
    v_mfma_f32_16x16x32_bf16 v[40:43], v[84:87], v[104:107], v[40:43]
    v_mfma_f32_16x16x32_bf16 v[44:47], v[84:87], v[108:111], v[44:47]
    v_mfma_f32_16x16x32_bf16 v[48:51], v[88:91], v[96:99], v[48:51]
    v_mfma_f32_16x16x32_bf16 v[52:55], v[88:91], v[100:103], v[52:55]
    v_mfma_f32_16x16x32_bf16 v[56:59], v[88:91], v[104:107], v[56:59]
    v_mfma_f32_16x16x32_bf16 v[60:63], v[88:91], v[108:111], v[60:63]
    v_mfma_f32_16x16x32_bf16 v[64:67], v[92:95], v[96:99], v[64:67]
    v_mfma_f32_16x16x32_bf16 v[68:71], v[92:95], v[100:103], v[68:71]
    v_mfma_f32_16x16x32_bf16 v[72:75], v[92:95], v[104:107], v[72:75]
    v_mfma_f32_16x16x32_bf16 v[76:79], v[92:95], v[108:111], v[76:79]
    s_add_u32 s4, s4, 4096
    s_addc_u32 s5, s5, 0
    s_add_u32 s6, s6, 4096
    s_addc_u32 s7, s7, 0
    global_load_dwordx4 v[80:83], v8, s[4:5] offset:0 sc1
    global_load_dwordx4 v[84:87], v9, s[4:5] offset:0 sc1
    global_load_dwordx4 v[88:91], v10, s[4:5] offset:0 sc1
    global_load_dwordx4 v[92:95], v11, s[4:5] offset:0 sc1
    global_load_dwordx4 v[96:99], v12, s[6:7] offset:0 sc1
    global_load_dwordx4 v[100:103], v13, s[6:7] offset:0 sc1
    global_load_dwordx4 v[104:107], v14, s[6:7] offset:0 sc1
    global_load_dwordx4 v[108:111], v15, s[6:7] offset:0 sc1
    s_waitcnt vmcnt(24)
    v_mfma_f32_16x16x32_bf16 v[16:19], v[112:115], v[128:131], v[16:19]
    v_mfma_f32_16x16x32_bf16 v[20:23], v[112:115], v[132:135], v[20:23]
    v_mfma_f32_16x16x32_bf16 v[24:27], v[112:115], v[136:139], v[24:27]
    v_mfma_f32_16x16x32_bf16 v[28:31], v[112:115], v[140:143], v[28:31]
    v_mfma_f32_16x16x32_bf16 v[32:35], v[116:119], v[128:131], v[32:35]
    v_mfma_f32_16x16x32_bf16 v[36:39], v[116:119], v[132:135], v[36:39]
    v_mfma_f32_16x16x32_bf16 v[40:43], v[116:119], v[136:139], v[40:43]
    v_mfma_f32_16x16x32_bf16 v[44:47], v[116:119], v[140:143], v[44:47]
    v_mfma_f32_16x16x32_bf16 v[48:51], v[120:123], v[128:131], v[48:51]
    v_mfma_f32_16x16x32_bf16 v[52:55], v[120:123], v[132:135], v[52:55]
    v_mfma_f32_16x16x32_bf16 v[56:59], v[120:123], v[136:139], v[56:59]
    v_mfma_f32_16x16x32_bf16 v[60:63], v[120:123], v[140:143], v[60:63]
    v_mfma_f32_16x16x32_bf16 v[64:67], v[124:127], v[128:131], v[64:67]
    v_mfma_f32_16x16x32_bf16 v[68:71], v[124:127], v[132:135], v[68:71]
    v_mfma_f32_16x16x32_bf16 v[72:75], v[124:127], v[136:139], v[72:75]
    v_mfma_f32_16x16x32_bf16 v[76:79], v[124:127], v[140:143], v[76:79]
    global_load_dwordx4 v[112:115], v8, s[4:5] offset:1024 sc1
    global_load_dwordx4 v[116:119], v9, s[4:5] offset:1024 sc1
    global_load_dwordx4 v[120:123], v10, s[4:5] offset:1024 sc1
    global_load_dwordx4 v[124:127], v11, s[4:5] offset:1024 sc1
    global_load_dwordx4 v[128:131], v12, s[6:7] offset:1024 sc1
    global_load_dwordx4 v[132:135], v13, s[6:7] offset:1024 sc1
    global_load_dwordx4 v[136:139], v14, s[6:7] offset:1024 sc1
    global_load_dwordx4 v[140:143], v15, s[6:7] offset:1024 sc1
    v_lshrrev_b32 v249, 2, v4
    v_lshl_add_u32 v249, v3, 4, v249
    v_add_u32 v250, s8, v249
    v_and_b32 v251, 3, v4
    v_mul_u32_u24 v5, 896, v250
    s_lshl_b32 s12, s9, 1
    v_lshl_add_u32 v6, v251, 5, s12
    v_add_u32 v5, v5, v6
    global_load_dwordx4 v[232:235], v5, s[16:17]
    global_load_dwordx4 v[236:239], v5, s[16:17] offset:16
    v_lshrrev_b32 v248, 4, v250
    v_mul_u32_u24 v248, 14336, v248
    v_and_b32 v7, 15, v250
    v_lshl_add_u32 v248, v7, 4, v248
    v_lshrrev_b32 v7, 6, v6
    v_lshl_add_u32 v248, v7, 10, v248
    v_bfe_u32 v7, v6, 4, 2
    v_lshl_add_u32 v248, v7, 8, v248
    global_load_dwordx4 v[240:243], v248, s[14:15] sc1
    global_load_dwordx4 v[244:247], v248, s[14:15] offset:256 sc1
    global_load_dwordx4 v[208:211], v6, s[18:19]
    global_load_dwordx4 v[212:215], v6, s[18:19] offset:16
    v_lshlrev_b32 v7, 11, v6
    v_lshl_add_u32 v252, v250, 1, v7
    v_and_b32 v253, 31, v0
    v_lshl_add_u32 v253, v253, 2, s78
    global_load_dword v254, v253, s[70:71] sc1
    v_mov_b32 v7, 0
    global_load_dword v255, v7, s[66:67] sc1
    s_waitcnt vmcnt(32)
    v_mfma_f32_16x16x32_bf16 v[16:19], v[144:147], v[160:163], v[16:19]
    v_mfma_f32_16x16x32_bf16 v[20:23], v[144:147], v[164:167], v[20:23]
    v_mfma_f32_16x16x32_bf16 v[24:27], v[144:147], v[168:171], v[24:27]
    v_mfma_f32_16x16x32_bf16 v[28:31], v[144:147], v[172:175], v[28:31]
    v_mfma_f32_16x16x32_bf16 v[32:35], v[148:151], v[160:163], v[32:35]
    v_mfma_f32_16x16x32_bf16 v[36:39], v[148:151], v[164:167], v[36:39]
    v_mfma_f32_16x16x32_bf16 v[40:43], v[148:151], v[168:171], v[40:43]
    v_mfma_f32_16x16x32_bf16 v[44:47], v[148:151], v[172:175], v[44:47]
    v_mfma_f32_16x16x32_bf16 v[48:51], v[152:155], v[160:163], v[48:51]
    v_mfma_f32_16x16x32_bf16 v[52:55], v[152:155], v[164:167], v[52:55]
    v_mfma_f32_16x16x32_bf16 v[56:59], v[152:155], v[168:171], v[56:59]
    v_mfma_f32_16x16x32_bf16 v[60:63], v[152:155], v[172:175], v[60:63]
    v_mfma_f32_16x16x32_bf16 v[64:67], v[156:159], v[160:163], v[64:67]
    v_mfma_f32_16x16x32_bf16 v[68:71], v[156:159], v[164:167], v[68:71]
    v_mfma_f32_16x16x32_bf16 v[72:75], v[156:159], v[168:171], v[72:75]
    v_mfma_f32_16x16x32_bf16 v[76:79], v[156:159], v[172:175], v[76:79]
    s_waitcnt vmcnt(24)
    v_mfma_f32_16x16x32_bf16 v[16:19], v[176:179], v[192:195], v[16:19]
    v_mfma_f32_16x16x32_bf16 v[20:23], v[176:179], v[196:199], v[20:23]
    v_mfma_f32_16x16x32_bf16 v[24:27], v[176:179], v[200:203], v[24:27]
    v_mfma_f32_16x16x32_bf16 v[28:31], v[176:179], v[204:207], v[28:31]
    v_mfma_f32_16x16x32_bf16 v[32:35], v[180:183], v[192:195], v[32:35]
    v_mfma_f32_16x16x32_bf16 v[36:39], v[180:183], v[196:199], v[36:39]
    v_mfma_f32_16x16x32_bf16 v[40:43], v[180:183], v[200:203], v[40:43]
    v_mfma_f32_16x16x32_bf16 v[44:47], v[180:183], v[204:207], v[44:47]
    v_mfma_f32_16x16x32_bf16 v[48:51], v[184:187], v[192:195], v[48:51]
    v_mfma_f32_16x16x32_bf16 v[52:55], v[184:187], v[196:199], v[52:55]
    v_mfma_f32_16x16x32_bf16 v[56:59], v[184:187], v[200:203], v[56:59]
    v_mfma_f32_16x16x32_bf16 v[60:63], v[184:187], v[204:207], v[60:63]
    v_mfma_f32_16x16x32_bf16 v[64:67], v[188:191], v[192:195], v[64:67]
    v_mfma_f32_16x16x32_bf16 v[68:71], v[188:191], v[196:199], v[68:71]
    v_mfma_f32_16x16x32_bf16 v[72:75], v[188:191], v[200:203], v[72:75]
    v_mfma_f32_16x16x32_bf16 v[76:79], v[188:191], v[204:207], v[76:79]
    s_waitcnt vmcnt(16)
    v_mfma_f32_16x16x32_bf16 v[16:19], v[80:83], v[96:99], v[16:19]
    v_mfma_f32_16x16x32_bf16 v[20:23], v[80:83], v[100:103], v[20:23]
    v_mfma_f32_16x16x32_bf16 v[24:27], v[80:83], v[104:107], v[24:27]
    v_mfma_f32_16x16x32_bf16 v[28:31], v[80:83], v[108:111], v[28:31]
    v_mfma_f32_16x16x32_bf16 v[32:35], v[84:87], v[96:99], v[32:35]
    v_mfma_f32_16x16x32_bf16 v[36:39], v[84:87], v[100:103], v[36:39]
    v_mfma_f32_16x16x32_bf16 v[40:43], v[84:87], v[104:107], v[40:43]
    v_mfma_f32_16x16x32_bf16 v[44:47], v[84:87], v[108:111], v[44:47]
    v_mfma_f32_16x16x32_bf16 v[48:51], v[88:91], v[96:99], v[48:51]
    v_mfma_f32_16x16x32_bf16 v[52:55], v[88:91], v[100:103], v[52:55]
    v_mfma_f32_16x16x32_bf16 v[56:59], v[88:91], v[104:107], v[56:59]
    v_mfma_f32_16x16x32_bf16 v[60:63], v[88:91], v[108:111], v[60:63]
    v_mfma_f32_16x16x32_bf16 v[64:67], v[92:95], v[96:99], v[64:67]
    v_mfma_f32_16x16x32_bf16 v[68:71], v[92:95], v[100:103], v[68:71]
    v_mfma_f32_16x16x32_bf16 v[72:75], v[92:95], v[104:107], v[72:75]
    v_mfma_f32_16x16x32_bf16 v[76:79], v[92:95], v[108:111], v[76:79]
    s_waitcnt vmcnt(8)
    v_mfma_f32_16x16x32_bf16 v[16:19], v[112:115], v[128:131], v[16:19]
    v_mfma_f32_16x16x32_bf16 v[20:23], v[112:115], v[132:135], v[20:23]
    v_mfma_f32_16x16x32_bf16 v[24:27], v[112:115], v[136:139], v[24:27]
    v_mfma_f32_16x16x32_bf16 v[28:31], v[112:115], v[140:143], v[28:31]
    v_mfma_f32_16x16x32_bf16 v[32:35], v[116:119], v[128:131], v[32:35]
    v_mfma_f32_16x16x32_bf16 v[36:39], v[116:119], v[132:135], v[36:39]
    v_mfma_f32_16x16x32_bf16 v[40:43], v[116:119], v[136:139], v[40:43]
    v_mfma_f32_16x16x32_bf16 v[44:47], v[116:119], v[140:143], v[44:47]
    v_mfma_f32_16x16x32_bf16 v[48:51], v[120:123], v[128:131], v[48:51]
    v_mfma_f32_16x16x32_bf16 v[52:55], v[120:123], v[132:135], v[52:55]
    v_mfma_f32_16x16x32_bf16 v[56:59], v[120:123], v[136:139], v[56:59]
    v_mfma_f32_16x16x32_bf16 v[60:63], v[120:123], v[140:143], v[60:63]
    v_mfma_f32_16x16x32_bf16 v[64:67], v[124:127], v[128:131], v[64:67]
    v_mfma_f32_16x16x32_bf16 v[68:71], v[124:127], v[132:135], v[68:71]
    v_mfma_f32_16x16x32_bf16 v[72:75], v[124:127], v[136:139], v[72:75]
    v_mfma_f32_16x16x32_bf16 v[76:79], v[124:127], v[140:143], v[76:79]
    s_waitcnt vmcnt(0)
A_ypoll:
    v_cmp_ne_u32 vcc, v255, v254
    s_cmp_eq_u64 vcc, 0
    s_cbranch_scc1 A_yok
    s_sleep 3
    global_load_dword v254, v253, s[70:71] sc1
    s_waitcnt vmcnt(0)
    s_branch A_ypoll
A_yok:
    global_load_ushort v216, v252, s[10:11] sc1
    v_add_u32 v252, 0x1000, v252
    global_load_ushort v217, v252, s[10:11] sc1
    v_add_u32 v252, 0x1000, v252
    global_load_ushort v218, v252, s[10:11] sc1
    v_add_u32 v252, 0x1000, v252
    global_load_ushort v219, v252, s[10:11] sc1
    v_add_u32 v252, 0x1000, v252
    global_load_ushort v220, v252, s[10:11] sc1
    v_add_u32 v252, 0x1000, v252
    global_load_ushort v221, v252, s[10:11] sc1
    v_add_u32 v252, 0x1000, v252
    global_load_ushort v222, v252, s[10:11] sc1
    v_add_u32 v252, 0x1000, v252
    global_load_ushort v223, v252, s[10:11] sc1
    v_add_u32 v252, 0x1000, v252
    global_load_ushort v224, v252, s[10:11] sc1
    v_add_u32 v252, 0x1000, v252
    global_load_ushort v225, v252, s[10:11] sc1
    v_add_u32 v252, 0x1000, v252
    global_load_ushort v226, v252, s[10:11] sc1
    v_add_u32 v252, 0x1000, v252
    global_load_ushort v227, v252, s[10:11] sc1
    v_add_u32 v252, 0x1000, v252
    global_load_ushort v228, v252, s[10:11] sc1
    v_add_u32 v252, 0x1000, v252
    global_load_ushort v229, v252, s[10:11] sc1
    v_add_u32 v252, 0x1000, v252
    global_load_ushort v230, v252, s[10:11] sc1
    v_add_u32 v252, 0x1000, v252
    global_load_ushort v231, v252, s[10:11] sc1
    v_lshl_add_u32 v6, v3, 6, v1
    v_mul_u32_u24 v6, 272, v6
    v_lshl_add_u32 v6, v2, 4, v6
    ds_write_b128 v6, v[16:19] offset:0
    ds_write_b128 v6, v[20:23] offset:4352
    ds_write_b128 v6, v[24:27] offset:8704
    ds_write_b128 v6, v[28:31] offset:13056
    ds_write_b128 v6, v[32:35] offset:64
    ds_write_b128 v6, v[36:39] offset:4416
    ds_write_b128 v6, v[40:43] offset:8768
    ds_write_b128 v6, v[44:47] offset:13120
    ds_write_b128 v6, v[48:51] offset:128
    ds_write_b128 v6, v[52:55] offset:4480
    ds_write_b128 v6, v[56:59] offset:8832
    ds_write_b128 v6, v[60:63] offset:13184
    ds_write_b128 v6, v[64:67] offset:192
    ds_write_b128 v6, v[68:71] offset:4544
    ds_write_b128 v6, v[72:75] offset:8896
    ds_write_b128 v6, v[76:79] offset:13248
    s_waitcnt lgkmcnt(0)
    s_barrier
    v_mul_u32_u24 v6, 272, v249
    v_lshl_add_u32 v6, v251, 6, v6
    ds_read_b128 v[80:83], v6 offset:0
    ds_read_b128 v[84:87], v6 offset:16
    ds_read_b128 v[88:91], v6 offset:32
    ds_read_b128 v[92:95], v6 offset:48
    ds_read_b128 v[96:99], v6 offset:17408
    ds_read_b128 v[100:103], v6 offset:17424
    ds_read_b128 v[104:107], v6 offset:17440
    ds_read_b128 v[108:111], v6 offset:17456
    ds_read_b128 v[112:115], v6 offset:34816
    ds_read_b128 v[116:119], v6 offset:34832
    ds_read_b128 v[120:123], v6 offset:34848
    ds_read_b128 v[124:127], v6 offset:34864
    ds_read_b128 v[128:131], v6 offset:52224
    ds_read_b128 v[132:135], v6 offset:52240
    ds_read_b128 v[136:139], v6 offset:52256
    ds_read_b128 v[140:143], v6 offset:52272
    s_mov_b32 s22, 0xbfb8aa3b
    s_waitcnt vmcnt(16) lgkmcnt(0)
    v_add_f32 v80, v80, v96
    v_add_f32 v81, v81, v97
    v_add_f32 v82, v82, v98
    v_add_f32 v83, v83, v99
    v_add_f32 v112, v112, v128
    v_add_f32 v113, v113, v129
    v_add_f32 v114, v114, v130
    v_add_f32 v115, v115, v131
    v_lshlrev_b32 v160, 16, v240
    v_and_b32 v161, 0xffff0000, v240
    v_lshlrev_b32 v162, 16, v241
    v_and_b32 v163, 0xffff0000, v241
    v_lshlrev_b32 v176, 16, v208
    v_and_b32 v177, 0xffff0000, v208
    v_lshlrev_b32 v178, 16, v209
    v_and_b32 v179, 0xffff0000, v209
    v_add_f32 v80, v80, v112
    v_add_f32 v81, v81, v113
    v_add_f32 v82, v82, v114
    v_add_f32 v83, v83, v115
    v_mul_f32 v160, v160, v176
    v_mul_f32 v161, v161, v177
    v_mul_f32 v162, v162, v178
    v_mul_f32 v163, v163, v179
    v_cvt_pk_bf16_f32 v80, v80, v80
    v_cvt_pk_bf16_f32 v81, v81, v81
    v_cvt_pk_bf16_f32 v82, v82, v82
    v_cvt_pk_bf16_f32 v83, v83, v83
    v_lshlrev_b32 v80, 16, v80
    v_lshlrev_b32 v81, 16, v81
    v_lshlrev_b32 v82, 16, v82
    v_lshlrev_b32 v83, 16, v83
    v_cvt_pk_bf16_f32 v160, v160, v160
    v_cvt_pk_bf16_f32 v161, v161, v161
    v_cvt_pk_bf16_f32 v162, v162, v162
    v_cvt_pk_bf16_f32 v163, v163, v163
    v_lshlrev_b32 v160, 16, v160
    v_lshlrev_b32 v161, 16, v161
    v_lshlrev_b32 v162, 16, v162
    v_lshlrev_b32 v163, 16, v163
    v_mul_f32 v144, s22, v80
    v_mul_f32 v145, s22, v81
    v_mul_f32 v146, s22, v82
    v_mul_f32 v147, s22, v83
    v_lshlrev_b32 v176, 16, v232
    v_and_b32 v177, 0xffff0000, v232
    v_lshlrev_b32 v178, 16, v233
    v_and_b32 v179, 0xffff0000, v233
    v_exp_f32 v144, v144
    v_exp_f32 v145, v145
    v_exp_f32 v146, v146
    v_exp_f32 v147, v147
    s_nop 0
    s_nop 0
    s_nop 0
    s_nop 0
    v_add_f32 v144, 1.0, v144
    v_add_f32 v145, 1.0, v145
    v_add_f32 v146, 1.0, v146
    v_add_f32 v147, 1.0, v147
    v_rcp_f32 v144, v144
    v_rcp_f32 v145, v145
    v_rcp_f32 v146, v146
    v_rcp_f32 v147, v147
    s_nop 0
    s_nop 0
    s_nop 0
    s_nop 0
    v_mul_f32 v80, v80, v144
    v_mul_f32 v81, v81, v145
    v_mul_f32 v82, v82, v146
    v_mul_f32 v83, v83, v147
    v_cvt_pk_bf16_f32 v80, v80, v80
    v_cvt_pk_bf16_f32 v81, v81, v81
    v_cvt_pk_bf16_f32 v82, v82, v82
    v_cvt_pk_bf16_f32 v83, v83, v83
    v_lshlrev_b32 v80, 16, v80
    v_lshlrev_b32 v81, 16, v81
    v_lshlrev_b32 v82, 16, v82
    v_lshlrev_b32 v83, 16, v83
    v_add_f32 v84, v84, v100
    v_add_f32 v85, v85, v101
    v_add_f32 v86, v86, v102
    v_add_f32 v87, v87, v103
    v_add_f32 v116, v116, v132
    v_add_f32 v117, v117, v133
    v_add_f32 v118, v118, v134
    v_add_f32 v119, v119, v135
    v_lshlrev_b32 v164, 16, v242
    v_and_b32 v165, 0xffff0000, v242
    v_lshlrev_b32 v166, 16, v243
    v_and_b32 v167, 0xffff0000, v243
    v_lshlrev_b32 v180, 16, v210
    v_and_b32 v181, 0xffff0000, v210
    v_lshlrev_b32 v182, 16, v211
    v_and_b32 v183, 0xffff0000, v211
    v_add_f32 v84, v84, v116
    v_add_f32 v85, v85, v117
    v_add_f32 v86, v86, v118
    v_add_f32 v87, v87, v119
    v_mul_f32 v164, v164, v180
    v_mul_f32 v165, v165, v181
    v_mul_f32 v166, v166, v182
    v_mul_f32 v167, v167, v183
    v_cvt_pk_bf16_f32 v84, v84, v84
    v_cvt_pk_bf16_f32 v85, v85, v85
    v_cvt_pk_bf16_f32 v86, v86, v86
    v_cvt_pk_bf16_f32 v87, v87, v87
    v_lshlrev_b32 v84, 16, v84
    v_lshlrev_b32 v85, 16, v85
    v_lshlrev_b32 v86, 16, v86
    v_lshlrev_b32 v87, 16, v87
    v_cvt_pk_bf16_f32 v164, v164, v164
    v_cvt_pk_bf16_f32 v165, v165, v165
    v_cvt_pk_bf16_f32 v166, v166, v166
    v_cvt_pk_bf16_f32 v167, v167, v167
    v_lshlrev_b32 v164, 16, v164
    v_lshlrev_b32 v165, 16, v165
    v_lshlrev_b32 v166, 16, v166
    v_lshlrev_b32 v167, 16, v167
    v_mul_f32 v148, s22, v84
    v_mul_f32 v149, s22, v85
    v_mul_f32 v150, s22, v86
    v_mul_f32 v151, s22, v87
    v_lshlrev_b32 v180, 16, v234
    v_and_b32 v181, 0xffff0000, v234
    v_lshlrev_b32 v182, 16, v235
    v_and_b32 v183, 0xffff0000, v235
    v_exp_f32 v148, v148
    v_exp_f32 v149, v149
    v_exp_f32 v150, v150
    v_exp_f32 v151, v151
    s_nop 0
    s_nop 0
    s_nop 0
    s_nop 0
    v_add_f32 v148, 1.0, v148
    v_add_f32 v149, 1.0, v149
    v_add_f32 v150, 1.0, v150
    v_add_f32 v151, 1.0, v151
    v_rcp_f32 v148, v148
    v_rcp_f32 v149, v149
    v_rcp_f32 v150, v150
    v_rcp_f32 v151, v151
    s_nop 0
    s_nop 0
    s_nop 0
    s_nop 0
    v_mul_f32 v84, v84, v148
    v_mul_f32 v85, v85, v149
    v_mul_f32 v86, v86, v150
    v_mul_f32 v87, v87, v151
    v_cvt_pk_bf16_f32 v84, v84, v84
    v_cvt_pk_bf16_f32 v85, v85, v85
    v_cvt_pk_bf16_f32 v86, v86, v86
    v_cvt_pk_bf16_f32 v87, v87, v87
    v_lshlrev_b32 v84, 16, v84
    v_lshlrev_b32 v85, 16, v85
    v_lshlrev_b32 v86, 16, v86
    v_lshlrev_b32 v87, 16, v87
    v_add_f32 v88, v88, v104
    v_add_f32 v89, v89, v105
    v_add_f32 v90, v90, v106
    v_add_f32 v91, v91, v107
    v_add_f32 v120, v120, v136
    v_add_f32 v121, v121, v137
    v_add_f32 v122, v122, v138
    v_add_f32 v123, v123, v139
    v_lshlrev_b32 v168, 16, v244
    v_and_b32 v169, 0xffff0000, v244
    v_lshlrev_b32 v170, 16, v245
    v_and_b32 v171, 0xffff0000, v245
    v_lshlrev_b32 v184, 16, v212
    v_and_b32 v185, 0xffff0000, v212
    v_lshlrev_b32 v186, 16, v213
    v_and_b32 v187, 0xffff0000, v213
    v_add_f32 v88, v88, v120
    v_add_f32 v89, v89, v121
    v_add_f32 v90, v90, v122
    v_add_f32 v91, v91, v123
    v_mul_f32 v168, v168, v184
    v_mul_f32 v169, v169, v185
    v_mul_f32 v170, v170, v186
    v_mul_f32 v171, v171, v187
    v_cvt_pk_bf16_f32 v88, v88, v88
    v_cvt_pk_bf16_f32 v89, v89, v89
    v_cvt_pk_bf16_f32 v90, v90, v90
    v_cvt_pk_bf16_f32 v91, v91, v91
    v_lshlrev_b32 v88, 16, v88
    v_lshlrev_b32 v89, 16, v89
    v_lshlrev_b32 v90, 16, v90
    v_lshlrev_b32 v91, 16, v91
    v_cvt_pk_bf16_f32 v168, v168, v168
    v_cvt_pk_bf16_f32 v169, v169, v169
    v_cvt_pk_bf16_f32 v170, v170, v170
    v_cvt_pk_bf16_f32 v171, v171, v171
    v_lshlrev_b32 v168, 16, v168
    v_lshlrev_b32 v169, 16, v169
    v_lshlrev_b32 v170, 16, v170
    v_lshlrev_b32 v171, 16, v171
    v_mul_f32 v152, s22, v88
    v_mul_f32 v153, s22, v89
    v_mul_f32 v154, s22, v90
    v_mul_f32 v155, s22, v91
    v_lshlrev_b32 v184, 16, v236
    v_and_b32 v185, 0xffff0000, v236
    v_lshlrev_b32 v186, 16, v237
    v_and_b32 v187, 0xffff0000, v237
    v_exp_f32 v152, v152
    v_exp_f32 v153, v153
    v_exp_f32 v154, v154
    v_exp_f32 v155, v155
    s_nop 0
    s_nop 0
    s_nop 0
    s_nop 0
    v_add_f32 v152, 1.0, v152
    v_add_f32 v153, 1.0, v153
    v_add_f32 v154, 1.0, v154
    v_add_f32 v155, 1.0, v155
    v_rcp_f32 v152, v152
    v_rcp_f32 v153, v153
    v_rcp_f32 v154, v154
    v_rcp_f32 v155, v155
    s_nop 0
    s_nop 0
    s_nop 0
    s_nop 0
    v_mul_f32 v88, v88, v152
    v_mul_f32 v89, v89, v153
    v_mul_f32 v90, v90, v154
    v_mul_f32 v91, v91, v155
    v_cvt_pk_bf16_f32 v88, v88, v88
    v_cvt_pk_bf16_f32 v89, v89, v89
    v_cvt_pk_bf16_f32 v90, v90, v90
    v_cvt_pk_bf16_f32 v91, v91, v91
    v_lshlrev_b32 v88, 16, v88
    v_lshlrev_b32 v89, 16, v89
    v_lshlrev_b32 v90, 16, v90
    v_lshlrev_b32 v91, 16, v91
    v_add_f32 v92, v92, v108
    v_add_f32 v93, v93, v109
    v_add_f32 v94, v94, v110
    v_add_f32 v95, v95, v111
    v_add_f32 v124, v124, v140
    v_add_f32 v125, v125, v141
    v_add_f32 v126, v126, v142
    v_add_f32 v127, v127, v143
    v_lshlrev_b32 v172, 16, v246
    v_and_b32 v173, 0xffff0000, v246
    v_lshlrev_b32 v174, 16, v247
    v_and_b32 v175, 0xffff0000, v247
    v_lshlrev_b32 v188, 16, v214
    v_and_b32 v189, 0xffff0000, v214
    v_lshlrev_b32 v190, 16, v215
    v_and_b32 v191, 0xffff0000, v215
    v_add_f32 v92, v92, v124
    v_add_f32 v93, v93, v125
    v_add_f32 v94, v94, v126
    v_add_f32 v95, v95, v127
    v_mul_f32 v172, v172, v188
    v_mul_f32 v173, v173, v189
    v_mul_f32 v174, v174, v190
    v_mul_f32 v175, v175, v191
    v_cvt_pk_bf16_f32 v92, v92, v92
    v_cvt_pk_bf16_f32 v93, v93, v93
    v_cvt_pk_bf16_f32 v94, v94, v94
    v_cvt_pk_bf16_f32 v95, v95, v95
    v_lshlrev_b32 v92, 16, v92
    v_lshlrev_b32 v93, 16, v93
    v_lshlrev_b32 v94, 16, v94
    v_lshlrev_b32 v95, 16, v95
    v_cvt_pk_bf16_f32 v172, v172, v172
    v_cvt_pk_bf16_f32 v173, v173, v173
    v_cvt_pk_bf16_f32 v174, v174, v174
    v_cvt_pk_bf16_f32 v175, v175, v175
    v_lshlrev_b32 v172, 16, v172
    v_lshlrev_b32 v173, 16, v173
    v_lshlrev_b32 v174, 16, v174
    v_lshlrev_b32 v175, 16, v175
    v_mul_f32 v156, s22, v92
    v_mul_f32 v157, s22, v93
    v_mul_f32 v158, s22, v94
    v_mul_f32 v159, s22, v95
    v_lshlrev_b32 v188, 16, v238
    v_and_b32 v189, 0xffff0000, v238
    v_lshlrev_b32 v190, 16, v239
    v_and_b32 v191, 0xffff0000, v239
    v_exp_f32 v156, v156
    v_exp_f32 v157, v157
    v_exp_f32 v158, v158
    v_exp_f32 v159, v159
    s_nop 0
    s_nop 0
    s_nop 0
    s_nop 0
    v_add_f32 v156, 1.0, v156
    v_add_f32 v157, 1.0, v157
    v_add_f32 v158, 1.0, v158
    v_add_f32 v159, 1.0, v159
    v_rcp_f32 v156, v156
    v_rcp_f32 v157, v157
    v_rcp_f32 v158, v158
    v_rcp_f32 v159, v159
    s_nop 0
    s_nop 0
    s_nop 0
    s_nop 0
    v_mul_f32 v92, v92, v156
    v_mul_f32 v93, v93, v157
    v_mul_f32 v94, v94, v158
    v_mul_f32 v95, v95, v159
    v_cvt_pk_bf16_f32 v92, v92, v92
    v_cvt_pk_bf16_f32 v93, v93, v93
    v_cvt_pk_bf16_f32 v94, v94, v94
    v_cvt_pk_bf16_f32 v95, v95, v95
    v_lshlrev_b32 v92, 16, v92
    v_lshlrev_b32 v93, 16, v93
    v_lshlrev_b32 v94, 16, v94
    v_lshlrev_b32 v95, 16, v95
    s_waitcnt vmcnt(0)
    v_lshlrev_b32 v144, 16, v216
    v_lshlrev_b32 v145, 16, v217
    v_lshlrev_b32 v146, 16, v218
    v_lshlrev_b32 v147, 16, v219
    v_add_f32 v160, v160, v144
    v_add_f32 v161, v161, v145
    v_add_f32 v162, v162, v146
    v_add_f32 v163, v163, v147
    v_cvt_pk_bf16_f32 v160, v160, v160
    v_cvt_pk_bf16_f32 v161, v161, v161
    v_cvt_pk_bf16_f32 v162, v162, v162
    v_cvt_pk_bf16_f32 v163, v163, v163
    v_lshlrev_b32 v160, 16, v160
    v_lshlrev_b32 v161, 16, v161
    v_lshlrev_b32 v162, 16, v162
    v_lshlrev_b32 v163, 16, v163
    v_mul_f32 v80, v80, v160
    v_mul_f32 v81, v81, v161
    v_mul_f32 v82, v82, v162
    v_mul_f32 v83, v83, v163
    v_cvt_pk_bf16_f32 v80, v80, v80
    v_cvt_pk_bf16_f32 v81, v81, v81
    v_cvt_pk_bf16_f32 v82, v82, v82
    v_cvt_pk_bf16_f32 v83, v83, v83
    v_lshlrev_b32 v80, 16, v80
    v_lshlrev_b32 v81, 16, v81
    v_lshlrev_b32 v82, 16, v82
    v_lshlrev_b32 v83, 16, v83
    v_add_f32 v80, v80, v176
    v_add_f32 v81, v81, v177
    v_add_f32 v82, v82, v178
    v_add_f32 v83, v83, v179
    v_lshlrev_b32 v148, 16, v220
    v_lshlrev_b32 v149, 16, v221
    v_lshlrev_b32 v150, 16, v222
    v_lshlrev_b32 v151, 16, v223
    v_add_f32 v164, v164, v148
    v_add_f32 v165, v165, v149
    v_add_f32 v166, v166, v150
    v_add_f32 v167, v167, v151
    v_cvt_pk_bf16_f32 v164, v164, v164
    v_cvt_pk_bf16_f32 v165, v165, v165
    v_cvt_pk_bf16_f32 v166, v166, v166
    v_cvt_pk_bf16_f32 v167, v167, v167
    v_lshlrev_b32 v164, 16, v164
    v_lshlrev_b32 v165, 16, v165
    v_lshlrev_b32 v166, 16, v166
    v_lshlrev_b32 v167, 16, v167
    v_mul_f32 v84, v84, v164
    v_mul_f32 v85, v85, v165
    v_mul_f32 v86, v86, v166
    v_mul_f32 v87, v87, v167
    v_cvt_pk_bf16_f32 v84, v84, v84
    v_cvt_pk_bf16_f32 v85, v85, v85
    v_cvt_pk_bf16_f32 v86, v86, v86
    v_cvt_pk_bf16_f32 v87, v87, v87
    v_lshlrev_b32 v84, 16, v84
    v_lshlrev_b32 v85, 16, v85
    v_lshlrev_b32 v86, 16, v86
    v_lshlrev_b32 v87, 16, v87
    v_add_f32 v84, v84, v180
    v_add_f32 v85, v85, v181
    v_add_f32 v86, v86, v182
    v_add_f32 v87, v87, v183
    v_lshlrev_b32 v152, 16, v224
    v_lshlrev_b32 v153, 16, v225
    v_lshlrev_b32 v154, 16, v226
    v_lshlrev_b32 v155, 16, v227
    v_add_f32 v168, v168, v152
    v_add_f32 v169, v169, v153
    v_add_f32 v170, v170, v154
    v_add_f32 v171, v171, v155
    v_cvt_pk_bf16_f32 v168, v168, v168
    v_cvt_pk_bf16_f32 v169, v169, v169
    v_cvt_pk_bf16_f32 v170, v170, v170
    v_cvt_pk_bf16_f32 v171, v171, v171
    v_lshlrev_b32 v168, 16, v168
    v_lshlrev_b32 v169, 16, v169
    v_lshlrev_b32 v170, 16, v170
    v_lshlrev_b32 v171, 16, v171
    v_mul_f32 v88, v88, v168
    v_mul_f32 v89, v89, v169
    v_mul_f32 v90, v90, v170
    v_mul_f32 v91, v91, v171
    v_cvt_pk_bf16_f32 v88, v88, v88
    v_cvt_pk_bf16_f32 v89, v89, v89
    v_cvt_pk_bf16_f32 v90, v90, v90
    v_cvt_pk_bf16_f32 v91, v91, v91
    v_lshlrev_b32 v88, 16, v88
    v_lshlrev_b32 v89, 16, v89
    v_lshlrev_b32 v90, 16, v90
    v_lshlrev_b32 v91, 16, v91
    v_add_f32 v88, v88, v184
    v_add_f32 v89, v89, v185
    v_add_f32 v90, v90, v186
    v_add_f32 v91, v91, v187
    v_lshlrev_b32 v156, 16, v228
    v_lshlrev_b32 v157, 16, v229
    v_lshlrev_b32 v158, 16, v230
    v_lshlrev_b32 v159, 16, v231
    v_add_f32 v172, v172, v156
    v_add_f32 v173, v173, v157
    v_add_f32 v174, v174, v158
    v_add_f32 v175, v175, v159
    v_cvt_pk_bf16_f32 v172, v172, v172
    v_cvt_pk_bf16_f32 v173, v173, v173
    v_cvt_pk_bf16_f32 v174, v174, v174
    v_cvt_pk_bf16_f32 v175, v175, v175
    v_lshlrev_b32 v172, 16, v172
    v_lshlrev_b32 v173, 16, v173
    v_lshlrev_b32 v174, 16, v174
    v_lshlrev_b32 v175, 16, v175
    v_mul_f32 v92, v92, v172
    v_mul_f32 v93, v93, v173
    v_mul_f32 v94, v94, v174
    v_mul_f32 v95, v95, v175
    v_cvt_pk_bf16_f32 v92, v92, v92
    v_cvt_pk_bf16_f32 v93, v93, v93
    v_cvt_pk_bf16_f32 v94, v94, v94
    v_cvt_pk_bf16_f32 v95, v95, v95
    v_lshlrev_b32 v92, 16, v92
    v_lshlrev_b32 v93, 16, v93
    v_lshlrev_b32 v94, 16, v94
    v_lshlrev_b32 v95, 16, v95
    v_add_f32 v92, v92, v188
    v_add_f32 v93, v93, v189
    v_add_f32 v94, v94, v190
    v_add_f32 v95, v95, v191
    v_cvt_pk_bf16_f32 v16, v80, v81
    v_cvt_pk_bf16_f32 v17, v82, v83
    v_cvt_pk_bf16_f32 v18, v84, v85
    v_cvt_pk_bf16_f32 v19, v86, v87
    v_cvt_pk_bf16_f32 v20, v88, v89
    v_cvt_pk_bf16_f32 v21, v90, v91
    v_cvt_pk_bf16_f32 v22, v92, v93
    v_cvt_pk_bf16_f32 v23, v94, v95
    global_store_dwordx4 v5, v[16:19], s[20:21]
    global_store_dwordx4 v5, v[20:23], s[20:21] offset:16
    s_endpgm
B_start:
    s_setprio 0
    s_sub_u32 s2, s2, 224
    s_lshl_b32 s3, s2, 10
    v_lshl_add_u32 v1, v0, 1, s3
    s_lshl_b32 s16, s2, 2
    v_mov_b32 v7, s16
    s_mov_b32 s20, 0x3fb8aa3b
    s_mov_b32 s21, 0x32a57060
    s_mov_b32 s22, 0x3f317218
    s_mov_b32 s23, 0x3e22f983
    s_mov_b32 s24, 0x31dc9c88
    s_waitcnt lgkmcnt(0)
    global_load_ushort v140, v1, s[6:7] offset:0
    global_load_ushort v141, v1, s[8:9] offset:0
    global_load_ushort v142, v1, s[10:11] offset:0
    global_load_ushort v143, v1, s[12:13] offset:0
    global_load_ushort v144, v7, s[14:15] offset:0
    global_load_ushort v145, v1, s[6:7] offset:512
    global_load_ushort v146, v1, s[8:9] offset:512
    global_load_ushort v147, v1, s[10:11] offset:512
    global_load_ushort v148, v1, s[12:13] offset:512
    global_load_ushort v149, v7, s[14:15] offset:2
    s_mov_b32 s74, 0
    v_mov_b32 v60, 0x80
    v_lshl_add_u32 v10, v0, 3, 0
    v_lshl_add_u32 v11, v0, 3, 1
    v_lshl_add_u32 v12, v0, 3, 2
    v_lshl_add_u32 v13, v0, 3, 3
    v_cvt_f32_u32 v10, v10
    v_cvt_f32_u32 v11, v11
    v_cvt_f32_u32 v12, v12
    v_cvt_f32_u32 v13, v13
    v_cvt_pk_bf16_f32 v10, v10, v10
    v_cvt_pk_bf16_f32 v11, v11, v11
    v_cvt_pk_bf16_f32 v12, v12, v12
    v_cvt_pk_bf16_f32 v13, v13, v13
    v_bfe_u32 v14, v10, 7, 8
    v_bfe_u32 v15, v11, 7, 8
    v_bfe_u32 v16, v12, 7, 8
    v_bfe_u32 v17, v13, 7, 8
    v_lshlrev_b32 v10, 16, v10
    v_lshlrev_b32 v11, 16, v11
    v_lshlrev_b32 v12, 16, v12
    v_lshlrev_b32 v13, 16, v13
    v_subrev_u32 v14, 134, v14
    v_subrev_u32 v15, 134, v15
    v_subrev_u32 v16, 134, v16
    v_subrev_u32 v17, 134, v17
    v_cvt_u32_f32 v10, v10
    v_cvt_u32_f32 v11, v11
    v_cvt_u32_f32 v12, v12
    v_cvt_u32_f32 v13, v13
    v_med3_i32 v14, v14, 0, 3
    v_med3_i32 v15, v15, 0, 3
    v_med3_i32 v16, v16, 0, 3
    v_med3_i32 v17, v17, 0, 3
    v_lshlrev_b32 v48, v14, v60
    v_lshlrev_b32 v49, v15, v60
    v_lshlrev_b32 v50, v16, v60
    v_lshlrev_b32 v51, v17, v60
    v_sub_u32 v56, 3, v14
    v_sub_u32 v57, 3, v15
    v_sub_u32 v58, 3, v16
    v_sub_u32 v59, 3, v17
    v_and_b32 v48, 0xffffff00, v48
    v_and_b32 v49, 0xffffff00, v49
    v_and_b32 v50, 0xffffff00, v50
    v_and_b32 v51, 0xffffff00, v51
    v_sub_u32 v10, v10, v48
    v_sub_u32 v11, v11, v49
    v_sub_u32 v12, v12, v50
    v_sub_u32 v13, v13, v51
    v_and_b32 v48, 7, v10
    v_and_b32 v49, 7, v11
    v_and_b32 v50, 7, v12
    v_and_b32 v51, 7, v13
    v_lshrrev_b32 v52, 7, v10
    v_lshrrev_b32 v53, 7, v11
    v_lshrrev_b32 v54, 7, v12
    v_lshrrev_b32 v55, 7, v13
    v_lshrrev_b32 v48, v14, v48
    v_lshrrev_b32 v49, v15, v49
    v_lshrrev_b32 v50, v16, v50
    v_lshrrev_b32 v51, v17, v51
    v_lshlrev_b32 v52, v56, v52
    v_lshlrev_b32 v53, v57, v53
    v_lshlrev_b32 v54, v58, v54
    v_lshlrev_b32 v55, v59, v55
    v_bfe_u32 v10, v10, 3, 4
    v_bfe_u32 v11, v11, 3, 4
    v_bfe_u32 v12, v12, 3, 4
    v_bfe_u32 v13, v13, 3, 4
    v_add_u32 v48, v48, v52
    v_add_u32 v49, v49, v53
    v_add_u32 v50, v50, v54
    v_add_u32 v51, v51, v55
    v_min_u32 v52, 1, v14
    v_min_u32 v53, 1, v15
    v_min_u32 v54, 1, v16
    v_min_u32 v55, 1, v17
    v_lshl_add_u32 v48, v48, 4, v10
    v_lshl_add_u32 v49, v49, 4, v11
    v_lshl_add_u32 v50, v50, 4, v12
    v_lshl_add_u32 v51, v51, 4, v13
    v_add_u32 v52, v52, v14
    v_add_u32 v53, v53, v15
    v_add_u32 v54, v54, v16
    v_add_u32 v55, v55, v17
    v_lshl_add_u32 v48, v52, 7, v48
    v_lshl_add_u32 v49, v53, 7, v49
    v_lshl_add_u32 v50, v54, 7, v50
    v_lshl_add_u32 v51, v55, 7, v51
    v_lshlrev_b32 v160, 2, v48
    v_lshlrev_b32 v161, 2, v49
    v_lshlrev_b32 v162, 2, v50
    v_lshlrev_b32 v163, 2, v51
    v_lshl_add_u32 v10, v0, 3, 4
    v_lshl_add_u32 v11, v0, 3, 5
    v_lshl_add_u32 v12, v0, 3, 6
    v_lshl_add_u32 v13, v0, 3, 7
    v_cvt_f32_u32 v10, v10
    v_cvt_f32_u32 v11, v11
    v_cvt_f32_u32 v12, v12
    v_cvt_f32_u32 v13, v13
    v_cvt_pk_bf16_f32 v10, v10, v10
    v_cvt_pk_bf16_f32 v11, v11, v11
    v_cvt_pk_bf16_f32 v12, v12, v12
    v_cvt_pk_bf16_f32 v13, v13, v13
    v_bfe_u32 v14, v10, 7, 8
    v_bfe_u32 v15, v11, 7, 8
    v_bfe_u32 v16, v12, 7, 8
    v_bfe_u32 v17, v13, 7, 8
    v_lshlrev_b32 v10, 16, v10
    v_lshlrev_b32 v11, 16, v11
    v_lshlrev_b32 v12, 16, v12
    v_lshlrev_b32 v13, 16, v13
    v_subrev_u32 v14, 134, v14
    v_subrev_u32 v15, 134, v15
    v_subrev_u32 v16, 134, v16
    v_subrev_u32 v17, 134, v17
    v_cvt_u32_f32 v10, v10
    v_cvt_u32_f32 v11, v11
    v_cvt_u32_f32 v12, v12
    v_cvt_u32_f32 v13, v13
    v_med3_i32 v14, v14, 0, 3
    v_med3_i32 v15, v15, 0, 3
    v_med3_i32 v16, v16, 0, 3
    v_med3_i32 v17, v17, 0, 3
    v_lshlrev_b32 v48, v14, v60
    v_lshlrev_b32 v49, v15, v60
    v_lshlrev_b32 v50, v16, v60
    v_lshlrev_b32 v51, v17, v60
    v_sub_u32 v56, 3, v14
    v_sub_u32 v57, 3, v15
    v_sub_u32 v58, 3, v16
    v_sub_u32 v59, 3, v17
    v_and_b32 v48, 0xffffff00, v48
    v_and_b32 v49, 0xffffff00, v49
    v_and_b32 v50, 0xffffff00, v50
    v_and_b32 v51, 0xffffff00, v51
    v_sub_u32 v10, v10, v48
    v_sub_u32 v11, v11, v49
    v_sub_u32 v12, v12, v50
    v_sub_u32 v13, v13, v51
    v_and_b32 v48, 7, v10
    v_and_b32 v49, 7, v11
    v_and_b32 v50, 7, v12
    v_and_b32 v51, 7, v13
    v_lshrrev_b32 v52, 7, v10
    v_lshrrev_b32 v53, 7, v11
    v_lshrrev_b32 v54, 7, v12
    v_lshrrev_b32 v55, 7, v13
    v_lshrrev_b32 v48, v14, v48
    v_lshrrev_b32 v49, v15, v49
    v_lshrrev_b32 v50, v16, v50
    v_lshrrev_b32 v51, v17, v51
    v_lshlrev_b32 v52, v56, v52
    v_lshlrev_b32 v53, v57, v53
    v_lshlrev_b32 v54, v58, v54
    v_lshlrev_b32 v55, v59, v55
    v_bfe_u32 v10, v10, 3, 4
    v_bfe_u32 v11, v11, 3, 4
    v_bfe_u32 v12, v12, 3, 4
    v_bfe_u32 v13, v13, 3, 4
    v_add_u32 v48, v48, v52
    v_add_u32 v49, v49, v53
    v_add_u32 v50, v50, v54
    v_add_u32 v51, v51, v55
    v_min_u32 v52, 1, v14
    v_min_u32 v53, 1, v15
    v_min_u32 v54, 1, v16
    v_min_u32 v55, 1, v17
    v_lshl_add_u32 v48, v48, 4, v10
    v_lshl_add_u32 v49, v49, 4, v11
    v_lshl_add_u32 v50, v50, 4, v12
    v_lshl_add_u32 v51, v51, 4, v13
    v_add_u32 v52, v52, v14
    v_add_u32 v53, v53, v15
    v_add_u32 v54, v54, v16
    v_add_u32 v55, v55, v17
    v_lshl_add_u32 v48, v52, 7, v48
    v_lshl_add_u32 v49, v53, 7, v49
    v_lshl_add_u32 v50, v54, 7, v50
    v_lshl_add_u32 v51, v55, 7, v51
    v_lshlrev_b32 v164, 2, v48
    v_lshlrev_b32 v165, 2, v49
    v_lshlrev_b32 v166, 2, v50
    v_lshlrev_b32 v167, 2, v51
    s_waitcnt vmcnt(0)
B_kloop:
    v_lshlrev_b32 v2, 16, v140
    v_lshlrev_b32 v3, 16, v141
    v_lshlrev_b32 v4, 16, v142
    v_lshlrev_b32 v5, 16, v143
    v_lshlrev_b32 v6, 16, v144
    v_mul_f32 v10, s20, v6
    v_fma_f32 v11, v6, s20, -v10
    v_fma_f32 v11, v6, s21, v11
    v_exp_f32 v8, v10
    v_mul_f32 v11, s22, v11
    v_fma_f32 v8, v8, v11, v8
    v_cvt_pk_bf16_f32 v8, v8, v8
    v_lshlrev_b32 v8, 16, v8
    v_mul_f32 v10, s20, v2
    v_fma_f32 v11, v2, s20, -v10
    v_fma_f32 v11, v2, s21, v11
    v_exp_f32 v9, v10
    v_mul_f32 v11, s22, v11
    v_fma_f32 v9, v9, v11, v9
    v_cvt_pk_bf16_f32 v9, v9, v9
    v_lshlrev_b32 v9, 16, v9
    v_mul_f32 v9, v9, v8
    v_mul_f32 v12, s20, v9
    v_sub_f32 v12, 0, v12
    v_mul_f32 v3, v3, v8
    v_mul_f32 v13, s23, v3
    v_fma_f32 v14, v3, s23, -v13
    v_fma_f32 v14, v3, s24, v14
    v_rndne_f32 v10, v13
    v_sub_f32 v10, v13, v10
    v_and_b32 v13, 0xffffff00, v10
    v_sub_f32 v10, v10, v13
    v_add_f32 v14, v10, v14
    v_mul_f32 v15, v4, v8
    v_add_f32 v15, v15, v15
    v_mul_f32 v16, v5, v8
    v_add_f32 v16, v16, v16
    v_and_b32 v2, 15, v0
    v_bfe_u32 v3, v0, 4, 2
    v_lshrrev_b32 v6, 6, v0
    v_mul_u32_u24 v6, 8704, v6
    v_add_u32 v6, 35072, v6
    v_and_b32 v4, 63, v0
    v_lshl_add_u32 v4, v4, 3, v6
    v_mul_u32_u24 v5, 528, v2
    v_lshl_add_u32 v5, v3, 4, v5
    v_add_u32 v5, v5, v6
    v_mul_f32 v104, 1.0, v12
    v_mul_f32 v106, 0x41000000, v12
    v_mul_f32 v108, 0x43000000, v12
    v_mul_f32 v105, 1.0, v13
    v_mul_f32 v107, 0x41000000, v13
    v_mul_f32 v109, 0x43000000, v13
    v_exp_f32 v104, v104
    v_exp_f32 v106, v106
    v_exp_f32 v108, v108
    v_fract_f32 v105, v105
    v_fract_f32 v107, v107
    v_fract_f32 v109, v109
    v_mov_b32 v22, 1.0
    v_mov_b32 v42, 0x41000000
    v_mov_b32 v18, 0x43000000
    v_fma_f32 v105, v22, v14, v105
    v_fma_f32 v107, v42, v14, v107
    v_fma_f32 v109, v18, v14, v109
    v_cos_f32 v22, v105
    v_cos_f32 v42, v107
    v_cos_f32 v18, v109
    v_sin_f32 v23, v105
    v_sin_f32 v43, v107
    v_sin_f32 v19, v109
    s_nop 0
    s_nop 0
    s_nop 0
    v_mul_f32 v22, v22, v104
    v_mul_f32 v42, v42, v106
    v_mul_f32 v18, v18, v108
    v_mul_f32 v23, v23, v104
    v_mul_f32 v43, v43, v106
    v_mul_f32 v19, v19, v108
    v_mov_b32 v40, 1.0
    v_mov_b32 v41, 0
    v_mul_f32 v44, v42, v42
    v_mul_f32 v24, v22, v22
    v_cvt_pk_bf16_f32 v112, v40, -v41
    v_cvt_pk_bf16_f32 v116, v42, -v43
    v_mul_f32 v45, v42, v43
    v_mul_f32 v25, v22, v23
    v_lshlrev_b32 v113, 16, v112
    v_lshlrev_b32 v117, 16, v116
    v_fma_f32 v44, -v43, v43, v44
    v_fma_f32 v24, -v23, v23, v24
    v_and_b32 v114, 0xffff0000, v112
    v_and_b32 v118, 0xffff0000, v116
    v_fma_f32 v45, v43, v42, v45
    v_fma_f32 v25, v23, v22, v25
    v_sub_f32 v113, v40, v113
    v_sub_f32 v117, v42, v117
    v_sub_f32 v114, -v41, v114
    v_sub_f32 v118, -v43, v118
    v_cvt_pk_bf16_f32 v113, v113, v114
    v_cvt_pk_bf16_f32 v117, v117, v118
    ds_write_b64 v4, v[112:113] offset:0
    ds_write_b64 v4, v[116:117] offset:528
    v_mul_f32 v46, v44, v42
    v_mul_f32 v48, v44, v44
    v_mul_f32 v26, v24, v22
    v_mul_f32 v28, v24, v24
    v_cvt_pk_bf16_f32 v112, v44, -v45
    v_mul_f32 v47, v44, v43
    v_mul_f32 v49, v44, v45
    v_mul_f32 v27, v24, v23
    v_mul_f32 v29, v24, v25
    v_lshlrev_b32 v113, 16, v112
    v_fma_f32 v46, -v45, v43, v46
    v_fma_f32 v48, -v45, v45, v48
    v_fma_f32 v26, -v25, v23, v26
    v_fma_f32 v28, -v25, v25, v28
    v_and_b32 v114, 0xffff0000, v112
    v_fma_f32 v47, v45, v42, v47
    v_fma_f32 v49, v45, v44, v49
    v_fma_f32 v27, v25, v22, v27
    v_fma_f32 v29, v25, v24, v29
    v_sub_f32 v113, v44, v113
    v_sub_f32 v114, -v45, v114
    v_cvt_pk_bf16_f32 v113, v113, v114
    ds_write_b64 v4, v[112:113] offset:1056
    v_mul_f32 v50, v48, v42
    v_mul_f32 v52, v46, v46
    v_mul_f32 v54, v48, v46
    v_mul_f32 v56, v48, v48
    v_cvt_pk_bf16_f32 v112, v46, -v47
    v_cvt_pk_bf16_f32 v116, v48, -v49
    v_mul_f32 v51, v48, v43
    v_mul_f32 v53, v46, v47
    v_mul_f32 v55, v48, v47
    v_mul_f32 v57, v48, v49
    v_lshlrev_b32 v113, 16, v112
    v_lshlrev_b32 v117, 16, v116
    v_fma_f32 v50, -v49, v43, v50
    v_fma_f32 v52, -v47, v47, v52
    v_fma_f32 v54, -v49, v47, v54
    v_fma_f32 v56, -v49, v49, v56
    v_and_b32 v114, 0xffff0000, v112
    v_and_b32 v118, 0xffff0000, v116
    v_fma_f32 v51, v49, v42, v51
    v_fma_f32 v53, v47, v46, v53
    v_fma_f32 v55, v49, v46, v55
    v_fma_f32 v57, v49, v48, v57
    v_sub_f32 v113, v46, v113
    v_sub_f32 v117, v48, v117
    v_sub_f32 v114, -v47, v114
    v_sub_f32 v118, -v49, v118
    v_cvt_pk_bf16_f32 v113, v113, v114
    v_cvt_pk_bf16_f32 v117, v117, v118
    ds_write_b64 v4, v[112:113] offset:1584
    ds_write_b64 v4, v[116:117] offset:2112
    v_mul_f32 v30, v28, v22
    v_mul_f32 v32, v26, v26
    v_mul_f32 v34, v28, v26
    v_mul_f32 v58, v56, v42
    v_mul_f32 v60, v56, v44
    v_mul_f32 v62, v56, v46
    v_cvt_pk_bf16_f32 v112, v50, -v51
    v_cvt_pk_bf16_f32 v116, v52, -v53
    v_mul_f32 v31, v28, v23
    v_mul_f32 v33, v26, v27
    v_mul_f32 v35, v28, v27
    v_mul_f32 v59, v56, v43
    v_mul_f32 v61, v56, v45
    v_mul_f32 v63, v56, v47
    v_lshlrev_b32 v113, 16, v112
    v_lshlrev_b32 v117, 16, v116
    v_fma_f32 v30, -v29, v23, v30
    v_fma_f32 v32, -v27, v27, v32
    v_fma_f32 v34, -v29, v27, v34
    v_fma_f32 v58, -v57, v43, v58
    v_fma_f32 v60, -v57, v45, v60
    v_fma_f32 v62, -v57, v47, v62
    v_and_b32 v114, 0xffff0000, v112
    v_and_b32 v118, 0xffff0000, v116
    v_fma_f32 v31, v29, v22, v31
    v_fma_f32 v33, v27, v26, v33
    v_fma_f32 v35, v29, v26, v35
    v_fma_f32 v59, v57, v42, v59
    v_fma_f32 v61, v57, v44, v61
    v_fma_f32 v63, v57, v46, v63
    v_sub_f32 v113, v50, v113
    v_sub_f32 v117, v52, v117
    v_sub_f32 v114, -v51, v114
    v_sub_f32 v118, -v53, v118
    v_cvt_pk_bf16_f32 v113, v113, v114
    v_cvt_pk_bf16_f32 v117, v117, v118
    ds_write_b64 v4, v[112:113] offset:2640
    ds_write_b64 v4, v[116:117] offset:3168
    v_mul_f32 v64, v56, v48
    v_mul_f32 v66, v56, v50
    v_mul_f32 v68, v56, v52
    v_mul_f32 v70, v56, v54
    v_cvt_pk_bf16_f32 v112, v54, -v55
    v_cvt_pk_bf16_f32 v116, v56, -v57
    v_cvt_pk_bf16_f32 v120, v58, -v59
    v_cvt_pk_bf16_f32 v136, v60, -v61
    v_mul_f32 v65, v56, v49
    v_mul_f32 v67, v56, v51
    v_mul_f32 v69, v56, v53
    v_mul_f32 v71, v56, v55
    v_lshlrev_b32 v113, 16, v112
    v_lshlrev_b32 v117, 16, v116
    v_lshlrev_b32 v121, 16, v120
    v_lshlrev_b32 v137, 16, v136
    v_fma_f32 v64, -v57, v49, v64
    v_fma_f32 v66, -v57, v51, v66
    v_fma_f32 v68, -v57, v53, v68
    v_fma_f32 v70, -v57, v55, v70
    v_and_b32 v114, 0xffff0000, v112
    v_and_b32 v118, 0xffff0000, v116
    v_and_b32 v122, 0xffff0000, v120
    v_and_b32 v138, 0xffff0000, v136
    v_fma_f32 v65, v57, v48, v65
    v_fma_f32 v67, v57, v50, v67
    v_fma_f32 v69, v57, v52, v69
    v_fma_f32 v71, v57, v54, v71
    v_sub_f32 v113, v54, v113
    v_sub_f32 v117, v56, v117
    v_sub_f32 v121, v58, v121
    v_sub_f32 v137, v60, v137
    v_sub_f32 v114, -v55, v114
    v_sub_f32 v118, -v57, v118
    v_sub_f32 v122, -v59, v122
    v_sub_f32 v138, -v61, v138
    v_cvt_pk_bf16_f32 v113, v113, v114
    v_cvt_pk_bf16_f32 v117, v117, v118
    v_cvt_pk_bf16_f32 v121, v121, v122
    v_cvt_pk_bf16_f32 v137, v137, v138
    ds_write_b64 v4, v[112:113] offset:3696
    ds_write_b64 v4, v[116:117] offset:4224
    ds_write_b64 v4, v[120:121] offset:4752
    ds_write_b64 v4, v[136:137] offset:5280
    v_cvt_pk_bf16_f32 v112, v62, -v63
    v_cvt_pk_bf16_f32 v116, v64, -v65
    v_cvt_pk_bf16_f32 v120, v66, -v67
    v_cvt_pk_bf16_f32 v136, v68, -v69
    v_lshlrev_b32 v113, 16, v112
    v_lshlrev_b32 v117, 16, v116
    v_lshlrev_b32 v121, 16, v120
    v_lshlrev_b32 v137, 16, v136
    v_and_b32 v114, 0xffff0000, v112
    v_and_b32 v118, 0xffff0000, v116
    v_and_b32 v122, 0xffff0000, v120
    v_and_b32 v138, 0xffff0000, v136
    v_sub_f32 v113, v62, v113
    v_sub_f32 v117, v64, v117
    v_sub_f32 v121, v66, v121
    v_sub_f32 v137, v68, v137
    v_sub_f32 v114, -v63, v114
    v_sub_f32 v118, -v65, v118
    v_sub_f32 v122, -v67, v122
    v_sub_f32 v138, -v69, v138
    v_cvt_pk_bf16_f32 v113, v113, v114
    v_cvt_pk_bf16_f32 v117, v117, v118
    v_cvt_pk_bf16_f32 v121, v121, v122
    v_cvt_pk_bf16_f32 v137, v137, v138
    ds_write_b64 v4, v[112:113] offset:5808
    ds_write_b64 v4, v[116:117] offset:6336
    ds_write_b64 v4, v[120:121] offset:6864
    ds_write_b64 v4, v[136:137] offset:7392
    v_cvt_pk_bf16_f32 v112, v70, -v71
    v_mul_f32 v38, v15, v18
    v_lshlrev_b32 v113, 16, v112
    v_mul_f32 v39, v15, v19
    v_and_b32 v114, 0xffff0000, v112
    v_fma_f32 v38, -v16, v19, v38
    v_sub_f32 v113, v70, v113
    v_fma_f32 v39, v16, v18, v39
    v_sub_f32 v114, -v71, v114
    v_cvt_pk_bf16_f32 v113, v113, v114
    ds_write_b64 v4, v[112:113] offset:7920
    v_mov_b32 v36, v15
    v_mov_b32 v37, v16
    s_waitcnt lgkmcnt(0)
    ds_read_b128 v[40:43], v5 offset:0
    ds_read_b128 v[44:47], v5 offset:64
    ds_read_b128 v[48:51], v5 offset:128
    ds_read_b128 v[52:55], v5 offset:192
    ds_read_b128 v[56:59], v5 offset:256
    ds_read_b128 v[60:63], v5 offset:320
    ds_read_b128 v[64:67], v5 offset:384
    ds_read_b128 v[68:71], v5 offset:448
    s_waitcnt lgkmcnt(0)
    v_mov_b32 v72, v40
    v_mov_b32 v73, v40
    v_mov_b32 v74, v42
    v_mov_b32 v75, v42
    v_mov_b32 v200, v41
    v_mov_b32 v201, v41
    v_mov_b32 v202, v43
    v_mov_b32 v203, v43
    v_mov_b32 v76, v44
    v_mov_b32 v77, v44
    v_mov_b32 v78, v46
    v_mov_b32 v79, v46
    v_mov_b32 v204, v45
    v_mov_b32 v205, v45
    v_mov_b32 v206, v47
    v_mov_b32 v207, v47
    v_mov_b32 v80, v48
    v_mov_b32 v81, v48
    v_mov_b32 v82, v50
    v_mov_b32 v83, v50
    v_mov_b32 v208, v49
    v_mov_b32 v209, v49
    v_mov_b32 v210, v51
    v_mov_b32 v211, v51
    v_mov_b32 v84, v52
    v_mov_b32 v85, v52
    v_mov_b32 v86, v54
    v_mov_b32 v87, v54
    v_mov_b32 v212, v53
    v_mov_b32 v213, v53
    v_mov_b32 v214, v55
    v_mov_b32 v215, v55
    v_mov_b32 v88, v56
    v_mov_b32 v89, v56
    v_mov_b32 v90, v58
    v_mov_b32 v91, v58
    v_mov_b32 v216, v57
    v_mov_b32 v217, v57
    v_mov_b32 v218, v59
    v_mov_b32 v219, v59
    v_mov_b32 v92, v60
    v_mov_b32 v93, v60
    v_mov_b32 v94, v62
    v_mov_b32 v95, v62
    v_mov_b32 v220, v61
    v_mov_b32 v221, v61
    v_mov_b32 v222, v63
    v_mov_b32 v223, v63
    v_mov_b32 v96, v64
    v_mov_b32 v97, v64
    v_mov_b32 v98, v66
    v_mov_b32 v99, v66
    v_mov_b32 v224, v65
    v_mov_b32 v225, v65
    v_mov_b32 v226, v67
    v_mov_b32 v227, v67
    v_mov_b32 v100, v68
    v_mov_b32 v101, v68
    v_mov_b32 v102, v70
    v_mov_b32 v103, v70
    v_mov_b32 v228, v69
    v_mov_b32 v229, v69
    v_mov_b32 v230, v71
    v_mov_b32 v231, v71
    v_cvt_pk_bf16_f32 v112, v36, v37
    v_mul_f32 v106, v36, v22
    v_mul_f32 v108, v36, v24
    v_mul_f32 v110, v36, v26
    v_mul_f32 v6, v38, v18
    v_lshlrev_b32 v113, 16, v112
    v_mul_f32 v107, v36, v23
    v_mul_f32 v109, v36, v25
    v_mul_f32 v111, v36, v27
    v_mul_f32 v7, v38, v19
    v_and_b32 v114, 0xffff0000, v112
    v_fma_f32 v106, -v37, v23, v106
    v_fma_f32 v108, -v37, v25, v108
    v_fma_f32 v110, -v37, v27, v110
    v_fma_f32 v6, -v39, v19, v6
    v_sub_f32 v113, v36, v113
    v_fma_f32 v107, v37, v22, v107
    v_fma_f32 v109, v37, v24, v109
    v_fma_f32 v111, v37, v26, v111
    v_fma_f32 v7, v39, v18, v7
    v_sub_f32 v114, v37, v114
    v_cvt_pk_bf16_f32 v116, v106, v107
    v_cvt_pk_bf16_f32 v120, v108, v109
    v_cvt_pk_bf16_f32 v136, v110, v111
    v_cvt_pk_bf16_f32 v113, v113, v114
    v_lshlrev_b32 v117, 16, v116
    v_lshlrev_b32 v121, 16, v120
    v_lshlrev_b32 v137, 16, v136
    ds_write_b64 v4, v[112:113] offset:0
    v_and_b32 v118, 0xffff0000, v116
    v_and_b32 v122, 0xffff0000, v120
    v_and_b32 v138, 0xffff0000, v136
    v_sub_f32 v117, v106, v117
    v_sub_f32 v121, v108, v121
    v_sub_f32 v137, v110, v137
    v_sub_f32 v118, v107, v118
    v_sub_f32 v122, v109, v122
    v_sub_f32 v138, v111, v138
    v_cvt_pk_bf16_f32 v117, v117, v118
    v_cvt_pk_bf16_f32 v121, v121, v122
    v_cvt_pk_bf16_f32 v137, v137, v138
    ds_write_b64 v4, v[116:117] offset:528
    ds_write_b64 v4, v[120:121] offset:1056
    ds_write_b64 v4, v[136:137] offset:1584
    v_mul_f32 v104, v36, v28
    v_mul_f32 v106, v36, v30
    v_mul_f32 v108, v36, v32
    v_mul_f32 v110, v36, v34
    v_mul_f32 v8, v6, v18
    v_mul_f32 v105, v36, v29
    v_mul_f32 v107, v36, v31
    v_mul_f32 v109, v36, v33
    v_mul_f32 v111, v36, v35
    v_mul_f32 v9, v6, v19
    v_fma_f32 v104, -v37, v29, v104
    v_fma_f32 v106, -v37, v31, v106
    v_fma_f32 v108, -v37, v33, v108
    v_fma_f32 v110, -v37, v35, v110
    v_fma_f32 v8, -v7, v19, v8
    v_fma_f32 v105, v37, v28, v105
    v_fma_f32 v107, v37, v30, v107
    v_fma_f32 v109, v37, v32, v109
    v_fma_f32 v111, v37, v34, v111
    v_fma_f32 v9, v7, v18, v9
    v_cvt_pk_bf16_f32 v112, v104, v105
    v_cvt_pk_bf16_f32 v116, v106, v107
    v_cvt_pk_bf16_f32 v120, v108, v109
    v_cvt_pk_bf16_f32 v136, v110, v111
    v_lshlrev_b32 v113, 16, v112
    v_lshlrev_b32 v117, 16, v116
    v_lshlrev_b32 v121, 16, v120
    v_lshlrev_b32 v137, 16, v136
    v_and_b32 v114, 0xffff0000, v112
    v_and_b32 v118, 0xffff0000, v116
    v_and_b32 v122, 0xffff0000, v120
    v_and_b32 v138, 0xffff0000, v136
    v_sub_f32 v113, v104, v113
    v_sub_f32 v117, v106, v117
    v_sub_f32 v121, v108, v121
    v_sub_f32 v137, v110, v137
    v_sub_f32 v114, v105, v114
    v_sub_f32 v118, v107, v118
    v_sub_f32 v122, v109, v122
    v_sub_f32 v138, v111, v138
    v_cvt_pk_bf16_f32 v113, v113, v114
    v_cvt_pk_bf16_f32 v117, v117, v118
    v_cvt_pk_bf16_f32 v121, v121, v122
    v_cvt_pk_bf16_f32 v137, v137, v138
    ds_write_b64 v4, v[112:113] offset:2112
    ds_write_b64 v4, v[116:117] offset:2640
    ds_write_b64 v4, v[120:121] offset:3168
    ds_write_b64 v4, v[136:137] offset:3696
    v_cvt_pk_bf16_f32 v112, v38, v39
    v_mul_f32 v106, v38, v22
    v_mul_f32 v108, v38, v24
    v_mul_f32 v110, v38, v26
    v_mul_f32 v10, v8, v18
    v_lshlrev_b32 v113, 16, v112
    v_mul_f32 v107, v38, v23
    v_mul_f32 v109, v38, v25
    v_mul_f32 v111, v38, v27
    v_mul_f32 v11, v8, v19
    v_and_b32 v114, 0xffff0000, v112
    v_fma_f32 v106, -v39, v23, v106
    v_fma_f32 v108, -v39, v25, v108
    v_fma_f32 v110, -v39, v27, v110
    v_fma_f32 v10, -v9, v19, v10
    v_sub_f32 v113, v38, v113
    v_fma_f32 v107, v39, v22, v107
    v_fma_f32 v109, v39, v24, v109
    v_fma_f32 v111, v39, v26, v111
    v_fma_f32 v11, v9, v18, v11
    v_sub_f32 v114, v39, v114
    v_cvt_pk_bf16_f32 v116, v106, v107
    v_cvt_pk_bf16_f32 v120, v108, v109
    v_cvt_pk_bf16_f32 v136, v110, v111
    v_cvt_pk_bf16_f32 v113, v113, v114
    v_lshlrev_b32 v117, 16, v116
    v_lshlrev_b32 v121, 16, v120
    v_lshlrev_b32 v137, 16, v136
    ds_write_b64 v4, v[112:113] offset:4224
    v_and_b32 v118, 0xffff0000, v116
    v_and_b32 v122, 0xffff0000, v120
    v_and_b32 v138, 0xffff0000, v136
    v_sub_f32 v117, v106, v117
    v_sub_f32 v121, v108, v121
    v_sub_f32 v137, v110, v137
    v_sub_f32 v118, v107, v118
    v_sub_f32 v122, v109, v122
    v_sub_f32 v138, v111, v138
    v_cvt_pk_bf16_f32 v117, v117, v118
    v_cvt_pk_bf16_f32 v121, v121, v122
    v_cvt_pk_bf16_f32 v137, v137, v138
    ds_write_b64 v4, v[116:117] offset:4752
    ds_write_b64 v4, v[120:121] offset:5280
    ds_write_b64 v4, v[136:137] offset:5808
    v_mul_f32 v104, v38, v28
    v_mul_f32 v106, v38, v30
    v_mul_f32 v108, v38, v32
    v_mul_f32 v110, v38, v34
    v_mul_f32 v105, v38, v29
    v_mul_f32 v107, v38, v31
    v_mul_f32 v109, v38, v33
    v_mul_f32 v111, v38, v35
    v_fma_f32 v104, -v39, v29, v104
    v_fma_f32 v106, -v39, v31, v106
    v_fma_f32 v108, -v39, v33, v108
    v_fma_f32 v110, -v39, v35, v110
    v_fma_f32 v105, v39, v28, v105
    v_fma_f32 v107, v39, v30, v107
    v_fma_f32 v109, v39, v32, v109
    v_fma_f32 v111, v39, v34, v111
    v_cvt_pk_bf16_f32 v112, v104, v105
    v_cvt_pk_bf16_f32 v116, v106, v107
    v_cvt_pk_bf16_f32 v120, v108, v109
    v_cvt_pk_bf16_f32 v136, v110, v111
    v_lshlrev_b32 v113, 16, v112
    v_lshlrev_b32 v117, 16, v116
    v_lshlrev_b32 v121, 16, v120
    v_lshlrev_b32 v137, 16, v136
    v_and_b32 v114, 0xffff0000, v112
    v_and_b32 v118, 0xffff0000, v116
    v_and_b32 v122, 0xffff0000, v120
    v_and_b32 v138, 0xffff0000, v136
    v_sub_f32 v113, v104, v113
    v_sub_f32 v117, v106, v117
    v_sub_f32 v121, v108, v121
    v_sub_f32 v137, v110, v137
    v_sub_f32 v114, v105, v114
    v_sub_f32 v118, v107, v118
    v_sub_f32 v122, v109, v122
    v_sub_f32 v138, v111, v138
    v_cvt_pk_bf16_f32 v113, v113, v114
    v_cvt_pk_bf16_f32 v117, v117, v118
    v_cvt_pk_bf16_f32 v121, v121, v122
    v_cvt_pk_bf16_f32 v137, v137, v138
    ds_write_b64 v4, v[112:113] offset:6336
    ds_write_b64 v4, v[116:117] offset:6864
    ds_write_b64 v4, v[120:121] offset:7392
    ds_write_b64 v4, v[136:137] offset:7920
    s_waitcnt lgkmcnt(0)
    ds_read_b128 v[40:43], v5 offset:0
    ds_read_b128 v[44:47], v5 offset:64
    ds_read_b128 v[48:51], v5 offset:128
    ds_read_b128 v[52:55], v5 offset:192
    ds_read_b128 v[56:59], v5 offset:256
    ds_read_b128 v[60:63], v5 offset:320
    ds_read_b128 v[64:67], v5 offset:384
    ds_read_b128 v[68:71], v5 offset:448
    s_waitcnt lgkmcnt(0)
    v_mfma_f32_16x16x32_bf16 v[124:127], v[40:43], v[72:75], 0
    v_cvt_pk_bf16_f32 v112, v6, v7
    v_mul_f32 v106, v6, v24
    v_mul_f32 v108, v6, v28
    v_mul_f32 v110, v6, v32
    v_mfma_f32_16x16x32_bf16 v[124:127], v[40:43], v[200:203], v[124:127]
    v_lshlrev_b32 v113, 16, v112
    v_mul_f32 v107, v6, v25
    v_mul_f32 v109, v6, v29
    v_mul_f32 v111, v6, v33
    v_mfma_f32_16x16x32_bf16 v[124:127], v[44:47], v[76:79], v[124:127]
    v_and_b32 v114, 0xffff0000, v112
    v_fma_f32 v106, -v7, v25, v106
    v_fma_f32 v108, -v7, v29, v108
    v_fma_f32 v110, -v7, v33, v110
    v_mfma_f32_16x16x32_bf16 v[124:127], v[44:47], v[204:207], v[124:127]
    v_sub_f32 v113, v6, v113
    v_fma_f32 v107, v7, v24, v107
    v_fma_f32 v109, v7, v28, v109
    v_fma_f32 v111, v7, v32, v111
    v_mfma_f32_16x16x32_bf16 v[124:127], v[48:51], v[80:83], v[124:127]
    v_sub_f32 v114, v7, v114
    v_cvt_pk_bf16_f32 v116, v106, v107
    v_cvt_pk_bf16_f32 v120, v108, v109
    v_cvt_pk_bf16_f32 v136, v110, v111
    v_mfma_f32_16x16x32_bf16 v[124:127], v[48:51], v[208:211], v[124:127]
    v_cvt_pk_bf16_f32 v113, v113, v114
    v_lshlrev_b32 v117, 16, v116
    v_lshlrev_b32 v121, 16, v120
    v_lshlrev_b32 v137, 16, v136
    v_mfma_f32_16x16x32_bf16 v[124:127], v[52:55], v[84:87], v[124:127]
    ds_write_b64 v4, v[112:113] offset:0
    v_and_b32 v118, 0xffff0000, v116
    v_and_b32 v122, 0xffff0000, v120
    v_and_b32 v138, 0xffff0000, v136
    v_mfma_f32_16x16x32_bf16 v[124:127], v[52:55], v[212:215], v[124:127]
    v_sub_f32 v117, v106, v117
    v_sub_f32 v121, v108, v121
    v_sub_f32 v137, v110, v137
    v_sub_f32 v118, v107, v118
    v_sub_f32 v122, v109, v122
    v_sub_f32 v138, v111, v138
    v_cvt_pk_bf16_f32 v117, v117, v118
    v_cvt_pk_bf16_f32 v121, v121, v122
    v_cvt_pk_bf16_f32 v137, v137, v138
    ds_write_b64 v4, v[116:117] offset:528
    ds_write_b64 v4, v[120:121] offset:1056
    ds_write_b64 v4, v[136:137] offset:1584
    v_mfma_f32_16x16x32_bf16 v[124:127], v[56:59], v[88:91], v[124:127]
    v_cvt_pk_bf16_f32 v112, v8, v9
    v_mul_f32 v106, v8, v24
    v_mul_f32 v108, v8, v28
    v_mul_f32 v110, v8, v32
    v_mul_f32 v36, v10, v18
    v_mfma_f32_16x16x32_bf16 v[124:127], v[56:59], v[216:219], v[124:127]
    v_lshlrev_b32 v113, 16, v112
    v_mul_f32 v107, v8, v25
    v_mul_f32 v109, v8, v29
    v_mul_f32 v111, v8, v33
    v_mul_f32 v37, v10, v19
    v_mfma_f32_16x16x32_bf16 v[124:127], v[60:63], v[92:95], v[124:127]
    v_and_b32 v114, 0xffff0000, v112
    v_fma_f32 v106, -v9, v25, v106
    v_fma_f32 v108, -v9, v29, v108
    v_fma_f32 v110, -v9, v33, v110
    v_fma_f32 v36, -v11, v19, v36
    v_mfma_f32_16x16x32_bf16 v[124:127], v[60:63], v[220:223], v[124:127]
    v_sub_f32 v113, v8, v113
    v_fma_f32 v107, v9, v24, v107
    v_fma_f32 v109, v9, v28, v109
    v_fma_f32 v111, v9, v32, v111
    v_fma_f32 v37, v11, v18, v37
    v_mfma_f32_16x16x32_bf16 v[124:127], v[64:67], v[96:99], v[124:127]
    v_sub_f32 v114, v9, v114
    v_cvt_pk_bf16_f32 v116, v106, v107
    v_cvt_pk_bf16_f32 v120, v108, v109
    v_cvt_pk_bf16_f32 v136, v110, v111
    v_mfma_f32_16x16x32_bf16 v[124:127], v[64:67], v[224:227], v[124:127]
    v_cvt_pk_bf16_f32 v113, v113, v114
    v_lshlrev_b32 v117, 16, v116
    v_lshlrev_b32 v121, 16, v120
    v_lshlrev_b32 v137, 16, v136
    v_mfma_f32_16x16x32_bf16 v[124:127], v[68:71], v[100:103], v[124:127]
    ds_write_b64 v4, v[112:113] offset:2112
    v_and_b32 v118, 0xffff0000, v116
    v_and_b32 v122, 0xffff0000, v120
    v_and_b32 v138, 0xffff0000, v136
    v_mfma_f32_16x16x32_bf16 v[124:127], v[68:71], v[228:231], v[124:127]
    v_sub_f32 v117, v106, v117
    v_sub_f32 v121, v108, v121
    v_sub_f32 v137, v110, v137
    v_sub_f32 v118, v107, v118
    v_sub_f32 v122, v109, v122
    v_sub_f32 v138, v111, v138
    v_cvt_pk_bf16_f32 v117, v117, v118
    v_cvt_pk_bf16_f32 v121, v121, v122
    v_cvt_pk_bf16_f32 v137, v137, v138
    ds_write_b64 v4, v[116:117] offset:2640
    ds_write_b64 v4, v[120:121] offset:3168
    ds_write_b64 v4, v[136:137] offset:3696
    v_cvt_pk_bf16_f32 v112, v10, v11
    v_mul_f32 v106, v10, v28
    v_cvt_pk_bf16_f32 v120, v36, v37
    v_mul_f32 v110, v36, v28
    v_mul_f32 v38, v36, v18
    v_lshlrev_b32 v113, 16, v112
    v_mul_f32 v107, v10, v29
    v_lshlrev_b32 v121, 16, v120
    v_mul_f32 v111, v36, v29
    v_mul_f32 v39, v36, v19
    v_and_b32 v114, 0xffff0000, v112
    v_fma_f32 v106, -v11, v29, v106
    v_and_b32 v122, 0xffff0000, v120
    v_fma_f32 v110, -v37, v29, v110
    v_fma_f32 v38, -v37, v19, v38
    v_sub_f32 v113, v10, v113
    v_fma_f32 v107, v11, v28, v107
    v_sub_f32 v121, v36, v121
    v_fma_f32 v111, v37, v28, v111
    v_fma_f32 v39, v37, v18, v39
    v_sub_f32 v114, v11, v114
    v_cvt_pk_bf16_f32 v116, v106, v107
    v_sub_f32 v122, v37, v122
    v_cvt_pk_bf16_f32 v136, v110, v111
    v_mul_f32 v6, v38, v18
    v_cvt_pk_bf16_f32 v113, v113, v114
    v_lshlrev_b32 v117, 16, v116
    v_cvt_pk_bf16_f32 v121, v121, v122
    v_lshlrev_b32 v137, 16, v136
    v_mul_f32 v7, v38, v19
    ds_write_b64 v4, v[112:113] offset:4224
    v_and_b32 v118, 0xffff0000, v116
    ds_write_b64 v4, v[120:121] offset:5280
    v_and_b32 v138, 0xffff0000, v136
    v_fma_f32 v6, -v39, v19, v6
    v_sub_f32 v117, v106, v117
    v_sub_f32 v137, v110, v137
    v_fma_f32 v7, v39, v18, v7
    v_sub_f32 v118, v107, v118
    v_sub_f32 v138, v111, v138
    v_cvt_pk_bf16_f32 v117, v117, v118
    v_cvt_pk_bf16_f32 v137, v137, v138
    ds_write_b64 v4, v[116:117] offset:4752
    ds_write_b64 v4, v[136:137] offset:5808
    v_cvt_pk_bf16_f32 v112, v38, v39
    v_mul_f32 v106, v38, v28
    v_cvt_pk_bf16_f32 v120, v6, v7
    v_mul_f32 v110, v6, v28
    v_mul_f32 v170, v6, v18
    v_lshlrev_b32 v113, 16, v112
    v_mul_f32 v107, v38, v29
    v_lshlrev_b32 v121, 16, v120
    v_mul_f32 v111, v6, v29
    v_mul_f32 v171, v6, v19
    v_and_b32 v114, 0xffff0000, v112
    v_fma_f32 v106, -v39, v29, v106
    v_and_b32 v122, 0xffff0000, v120
    v_fma_f32 v110, -v7, v29, v110
    v_fma_f32 v170, -v7, v19, v170
    v_sub_f32 v113, v38, v113
    v_fma_f32 v107, v39, v28, v107
    v_sub_f32 v121, v6, v121
    v_fma_f32 v111, v7, v28, v111
    v_fma_f32 v171, v7, v18, v171
    v_sub_f32 v114, v39, v114
    v_cvt_pk_bf16_f32 v116, v106, v107
    v_sub_f32 v122, v7, v122
    v_cvt_pk_bf16_f32 v136, v110, v111
    v_mul_f32 v172, v170, v18
    v_cvt_pk_bf16_f32 v113, v113, v114
    v_lshlrev_b32 v117, 16, v116
    v_cvt_pk_bf16_f32 v121, v121, v122
    v_lshlrev_b32 v137, 16, v136
    v_mul_f32 v173, v170, v19
    ds_write_b64 v4, v[112:113] offset:6336
    v_and_b32 v118, 0xffff0000, v116
    ds_write_b64 v4, v[120:121] offset:7392
    v_and_b32 v138, 0xffff0000, v136
    v_fma_f32 v172, -v171, v19, v172
    v_sub_f32 v117, v106, v117
    v_sub_f32 v137, v110, v137
    v_fma_f32 v173, v171, v18, v173
    v_sub_f32 v118, v107, v118
    v_sub_f32 v138, v111, v138
    v_mul_f32 v174, v172, v18
    v_cvt_pk_bf16_f32 v117, v117, v118
    v_cvt_pk_bf16_f32 v137, v137, v138
    v_mul_f32 v175, v172, v19
    ds_write_b64 v4, v[116:117] offset:6864
    ds_write_b64 v4, v[136:137] offset:7920
    v_fma_f32 v174, -v173, v19, v174
    v_fma_f32 v175, v173, v18, v175
    s_waitcnt lgkmcnt(0)
    ds_read_b128 v[40:43], v5 offset:0
    ds_read_b128 v[44:47], v5 offset:64
    ds_read_b128 v[48:51], v5 offset:128
    ds_read_b128 v[52:55], v5 offset:192
    ds_read_b128 v[56:59], v5 offset:256
    ds_read_b128 v[60:63], v5 offset:320
    ds_read_b128 v[64:67], v5 offset:384
    ds_read_b128 v[68:71], v5 offset:448
    s_waitcnt lgkmcnt(0)
    v_cvt_pk_bf16_f32 v112, v170, v171
    v_cvt_pk_bf16_f32 v116, v172, v173
    v_cvt_pk_bf16_f32 v120, v174, v175
    v_mul_f32 v176, v174, v18
    v_mfma_f32_16x16x32_bf16 v[128:131], v[40:43], v[72:75], 0
    v_lshlrev_b32 v113, 16, v112
    v_lshlrev_b32 v117, 16, v116
    v_lshlrev_b32 v121, 16, v120
    v_mul_f32 v177, v174, v19
    v_mfma_f32_16x16x32_bf16 v[128:131], v[40:43], v[200:203], v[128:131]
    v_and_b32 v114, 0xffff0000, v112
    v_and_b32 v118, 0xffff0000, v116
    v_and_b32 v122, 0xffff0000, v120
    v_fma_f32 v176, -v175, v19, v176
    v_mfma_f32_16x16x32_bf16 v[128:131], v[44:47], v[76:79], v[128:131]
    v_sub_f32 v113, v170, v113
    v_sub_f32 v117, v172, v117
    v_sub_f32 v121, v174, v121
    v_fma_f32 v177, v175, v18, v177
    v_mfma_f32_16x16x32_bf16 v[128:131], v[44:47], v[204:207], v[128:131]
    v_sub_f32 v114, v171, v114
    v_sub_f32 v118, v173, v118
    v_sub_f32 v122, v175, v122
    v_mul_f32 v178, v176, v18
    v_mfma_f32_16x16x32_bf16 v[128:131], v[48:51], v[80:83], v[128:131]
    v_cvt_pk_bf16_f32 v113, v113, v114
    v_cvt_pk_bf16_f32 v117, v117, v118
    v_cvt_pk_bf16_f32 v121, v121, v122
    v_mul_f32 v179, v176, v19
    v_mfma_f32_16x16x32_bf16 v[128:131], v[48:51], v[208:211], v[128:131]
    ds_write_b64 v4, v[112:113] offset:0
    ds_write_b64 v4, v[116:117] offset:528
    ds_write_b64 v4, v[120:121] offset:1056
    v_fma_f32 v178, -v177, v19, v178
    v_mfma_f32_16x16x32_bf16 v[128:131], v[52:55], v[84:87], v[128:131]
    v_fma_f32 v179, v177, v18, v179
    v_mfma_f32_16x16x32_bf16 v[128:131], v[52:55], v[212:215], v[128:131]
    v_mul_f32 v180, v178, v18
    v_mul_f32 v181, v178, v19
    v_fma_f32 v180, -v179, v19, v180
    v_fma_f32 v181, v179, v18, v181
    v_cvt_pk_bf16_f32 v112, v176, v177
    v_cvt_pk_bf16_f32 v116, v178, v179
    v_cvt_pk_bf16_f32 v120, v180, v181
    v_mul_f32 v182, v180, v18
    v_mfma_f32_16x16x32_bf16 v[128:131], v[56:59], v[88:91], v[128:131]
    v_lshlrev_b32 v113, 16, v112
    v_lshlrev_b32 v117, 16, v116
    v_lshlrev_b32 v121, 16, v120
    v_mul_f32 v183, v180, v19
    v_mfma_f32_16x16x32_bf16 v[128:131], v[56:59], v[216:219], v[128:131]
    v_and_b32 v114, 0xffff0000, v112
    v_and_b32 v118, 0xffff0000, v116
    v_and_b32 v122, 0xffff0000, v120
    v_fma_f32 v182, -v181, v19, v182
    v_mfma_f32_16x16x32_bf16 v[128:131], v[60:63], v[92:95], v[128:131]
    v_sub_f32 v113, v176, v113
    v_sub_f32 v117, v178, v117
    v_sub_f32 v121, v180, v121
    v_fma_f32 v183, v181, v18, v183
    v_mfma_f32_16x16x32_bf16 v[128:131], v[60:63], v[220:223], v[128:131]
    v_sub_f32 v114, v177, v114
    v_sub_f32 v118, v179, v118
    v_sub_f32 v122, v181, v122
    v_mul_f32 v184, v182, v18
    v_mfma_f32_16x16x32_bf16 v[128:131], v[64:67], v[96:99], v[128:131]
    v_cvt_pk_bf16_f32 v113, v113, v114
    v_cvt_pk_bf16_f32 v117, v117, v118
    v_cvt_pk_bf16_f32 v121, v121, v122
    v_mul_f32 v185, v182, v19
    v_mfma_f32_16x16x32_bf16 v[128:131], v[64:67], v[224:227], v[128:131]
    ds_write_b64 v4, v[112:113] offset:1584
    ds_write_b64 v4, v[116:117] offset:2112
    ds_write_b64 v4, v[120:121] offset:2640
    v_fma_f32 v184, -v183, v19, v184
    v_mfma_f32_16x16x32_bf16 v[128:131], v[68:71], v[100:103], v[128:131]
    v_fma_f32 v185, v183, v18, v185
    v_mfma_f32_16x16x32_bf16 v[128:131], v[68:71], v[228:231], v[128:131]
    v_mul_f32 v186, v184, v18
    v_mul_f32 v187, v184, v19
    v_fma_f32 v186, -v185, v19, v186
    v_fma_f32 v187, v185, v18, v187
    v_cvt_pk_bf16_f32 v112, v182, v183
    v_cvt_pk_bf16_f32 v116, v184, v185
    v_cvt_pk_bf16_f32 v120, v186, v187
    v_lshlrev_b32 v113, 16, v112
    v_lshlrev_b32 v117, 16, v116
    v_lshlrev_b32 v121, 16, v120
    v_and_b32 v114, 0xffff0000, v112
    v_and_b32 v118, 0xffff0000, v116
    v_and_b32 v122, 0xffff0000, v120
    v_sub_f32 v113, v182, v113
    v_sub_f32 v117, v184, v117
    v_sub_f32 v121, v186, v121
    v_sub_f32 v114, v183, v114
    v_sub_f32 v118, v185, v118
    v_sub_f32 v122, v187, v122
    v_cvt_pk_bf16_f32 v113, v113, v114
    v_cvt_pk_bf16_f32 v117, v117, v118
    v_cvt_pk_bf16_f32 v121, v121, v122
    ds_write_b64 v4, v[112:113] offset:3168
    ds_write_b64 v4, v[116:117] offset:3696
    ds_write_b64 v4, v[120:121] offset:4224
    s_waitcnt lgkmcnt(0)
    ds_read_b128 v[40:43], v5 offset:0
    ds_read_b128 v[44:47], v5 offset:64
    ds_read_b128 v[48:51], v5 offset:128
    ds_read_b128 v[52:55], v5 offset:192
    ds_read_b128 v[56:59], v5 offset:256
    ds_read_b128 v[60:63], v5 offset:320
    ds_read_b128 v[64:67], v5 offset:384
    ds_read_b128 v[68:71], v5 offset:448
    s_waitcnt lgkmcnt(0)
    v_mfma_f32_16x16x32_bf16 v[132:135], v[40:43], v[72:75], 0
    v_mfma_f32_16x16x32_bf16 v[132:135], v[40:43], v[200:203], v[132:135]
    v_mfma_f32_16x16x32_bf16 v[132:135], v[44:47], v[76:79], v[132:135]
    v_mfma_f32_16x16x32_bf16 v[132:135], v[44:47], v[204:207], v[132:135]
    v_mfma_f32_16x16x32_bf16 v[132:135], v[48:51], v[80:83], v[132:135]
    v_mfma_f32_16x16x32_bf16 v[132:135], v[48:51], v[208:211], v[132:135]
    v_mfma_f32_16x16x32_bf16 v[132:135], v[52:55], v[84:87], v[132:135]
    v_mfma_f32_16x16x32_bf16 v[132:135], v[52:55], v[212:215], v[132:135]
    v_mfma_f32_16x16x32_bf16 v[132:135], v[56:59], v[88:91], v[132:135]
    v_mfma_f32_16x16x32_bf16 v[132:135], v[56:59], v[216:219], v[132:135]
    v_mfma_f32_16x16x32_bf16 v[132:135], v[60:63], v[92:95], v[132:135]
    v_mfma_f32_16x16x32_bf16 v[132:135], v[60:63], v[220:223], v[132:135]
    v_mfma_f32_16x16x32_bf16 v[132:135], v[64:67], v[96:99], v[132:135]
    v_mfma_f32_16x16x32_bf16 v[132:135], v[64:67], v[224:227], v[132:135]
    v_mfma_f32_16x16x32_bf16 v[132:135], v[68:71], v[100:103], v[132:135]
    v_mfma_f32_16x16x32_bf16 v[132:135], v[68:71], v[228:231], v[132:135]
    s_nop 7
    s_nop 1
    v_lshrrev_b32 v19, 6, v0
    v_mul_u32_u24 v19, 8704, v19
    v_lshl_add_u32 v19, v3, 8, v19
    v_lshl_add_u32 v19, v2, 2, v19
    ds_write_b32 v19, v124 offset:35072
    ds_write_b32 v19, v125 offset:35136
    ds_write_b32 v19, v126 offset:35200
    ds_write_b32 v19, v127 offset:35264
    ds_write_b32 v19, v128 offset:36096
    ds_write_b32 v19, v129 offset:36160
    ds_write_b32 v19, v130 offset:36224
    ds_write_b32 v19, v131 offset:36288
    ds_write_b32 v19, v132 offset:37120
    ds_write_b32 v19, v133 offset:37184
    ds_write_b32 v19, v134 offset:37248
    ds_write_b32 v19, v135 offset:37312
    s_waitcnt lgkmcnt(0)
    s_barrier
    ds_read_b32 v16, v160 offset:35072
    ds_read_b32 v17, v160 offset:43776
    ds_read_b32 v18, v160 offset:52480
    ds_read_b32 v19, v160 offset:61184
    ds_read_b32 v20, v161 offset:35072
    ds_read_b32 v21, v161 offset:43776
    ds_read_b32 v22, v161 offset:52480
    ds_read_b32 v23, v161 offset:61184
    ds_read_b32 v24, v162 offset:35072
    ds_read_b32 v25, v162 offset:43776
    ds_read_b32 v26, v162 offset:52480
    ds_read_b32 v27, v162 offset:61184
    ds_read_b32 v28, v163 offset:35072
    ds_read_b32 v29, v163 offset:43776
    ds_read_b32 v30, v163 offset:52480
    ds_read_b32 v31, v163 offset:61184
    s_waitcnt lgkmcnt(0)
    ds_read_b32 v32, v164 offset:35072
    ds_read_b32 v33, v164 offset:43776
    ds_read_b32 v34, v164 offset:52480
    ds_read_b32 v35, v164 offset:61184
    ds_read_b32 v36, v165 offset:35072
    ds_read_b32 v37, v165 offset:43776
    ds_read_b32 v38, v165 offset:52480
    ds_read_b32 v39, v165 offset:61184
    ds_read_b32 v40, v166 offset:35072
    ds_read_b32 v41, v166 offset:43776
    ds_read_b32 v42, v166 offset:52480
    ds_read_b32 v43, v166 offset:61184
    ds_read_b32 v44, v167 offset:35072
    ds_read_b32 v45, v167 offset:43776
    ds_read_b32 v46, v167 offset:52480
    ds_read_b32 v47, v167 offset:61184
    s_waitcnt lgkmcnt(0)
    v_add_f32 v16, v16, v17
    v_add_f32 v18, v18, v19
    v_add_f32 v16, v16, v18
    v_add_f32 v20, v20, v21
    v_add_f32 v22, v22, v23
    v_add_f32 v20, v20, v22
    v_add_f32 v24, v24, v25
    v_add_f32 v26, v26, v27
    v_add_f32 v24, v24, v26
    v_add_f32 v28, v28, v29
    v_add_f32 v30, v30, v31
    v_add_f32 v28, v28, v30
    v_add_f32 v32, v32, v33
    v_add_f32 v34, v34, v35
    v_add_f32 v32, v32, v34
    v_add_f32 v36, v36, v37
    v_add_f32 v38, v38, v39
    v_add_f32 v36, v36, v38
    v_add_f32 v40, v40, v41
    v_add_f32 v42, v42, v43
    v_add_f32 v40, v40, v42
    v_add_f32 v44, v44, v45
    v_add_f32 v46, v46, v47
    v_add_f32 v44, v44, v46
    v_cvt_pk_bf16_f32 v48, v44, v40
    v_lshlrev_b32 v10, 16, v48
    v_and_b32 v11, 0xffff0000, v48
    v_sub_f32 v10, v44, v10
    v_sub_f32 v11, v40, v11
    v_cvt_pk_bf16_f32 v52, v10, v11
    v_cvt_pk_bf16_f32 v49, v36, v32
    v_lshlrev_b32 v10, 16, v49
    v_and_b32 v11, 0xffff0000, v49
    v_sub_f32 v10, v36, v10
    v_sub_f32 v11, v32, v11
    v_cvt_pk_bf16_f32 v53, v10, v11
    v_cvt_pk_bf16_f32 v50, v28, v24
    v_lshlrev_b32 v10, 16, v50
    v_and_b32 v11, 0xffff0000, v50
    v_sub_f32 v10, v28, v10
    v_sub_f32 v11, v24, v11
    v_cvt_pk_bf16_f32 v54, v10, v11
    v_cvt_pk_bf16_f32 v51, v20, v16
    v_lshlrev_b32 v10, 16, v51
    v_and_b32 v11, 0xffff0000, v51
    v_sub_f32 v10, v20, v10
    v_sub_f32 v11, v16, v11
    v_cvt_pk_bf16_f32 v55, v10, v11
    v_lshlrev_b32 v10, 4, v0
    v_sub_u32 v10, 4080, v10
    v_add_u32 v10, s74, v10
    ds_write_b128 v10, v[48:51]
    ds_write_b128 v10, v[52:55] offset:4608
    v_cmp_gt_u32 vcc, 64, v0
    s_and_saveexec_b64 s[18:19], vcc
    v_and_b32 v10, 31, v0
    v_lshlrev_b32 v10, 4, v10
    v_lshrrev_b32 v11, 5, v0
    v_mul_u32_u24 v11, 4608, v11
    v_add3_u32 v10, v10, v11, s74
    v_mov_b32 v12, 0
    v_mov_b32 v13, 0
    v_mov_b32 v14, 0
    v_mov_b32 v15, 0
    ds_write_b128 v10, v[12:15] offset:4096
    s_mov_b64 exec, s[18:19]
    s_waitcnt lgkmcnt(0)
    s_barrier
    v_mov_b32 v140, v145
    v_mov_b32 v141, v146
    v_mov_b32 v142, v147
    v_mov_b32 v143, v148
    v_mov_b32 v144, v149
    s_add_u32 s74, s74, 9216
    s_cmp_eq_u32 s74, 18432
    s_cbranch_scc1 B_kdone
    s_mov_b32 s76, 0
    s_mov_b32 s77, 256
    s_cmp_lg_u32 s69, 0
    s_cbranch_scc1 W_end_30
    s_cmp_lg_u32 s68, 0
    s_cbranch_scc1 N_ok_32
    s_waitcnt vmcnt(0)
    v_readfirstlane_b32 s68, v255
    s_cmp_lg_u32 s68, 0
    s_cbranch_scc1 N_ok_32
    v_mov_b32 v253, 0
N_poll_31:
    global_load_dword v254, v253, s[66:67] sc1
    s_waitcnt vmcnt(0)
    v_readfirstlane_b32 s68, v254
    s_cmp_lg_u32 s68, 0
    s_cbranch_scc1 N_ok_32
    s_sleep 4
    s_branch N_poll_31
N_ok_32:
    v_and_b32 v253, 63, v0
    v_min_u32 v253, 63, v253
    v_lshl_add_u32 v253, v253, 2, s76
W_poll_33:
    global_load_dword v254, v253, s[70:71] sc1
    s_waitcnt vmcnt(0)
    v_cmp_ne_u32 vcc, s68, v254
    s_cmp_eq_u64 vcc, 0
    s_cbranch_scc1 W_ok_34
    s_sleep 3
    s_branch W_poll_33
W_ok_34:
    v_and_b32 v253, 63, v0
    v_min_u32 v253, 63, v253
    v_lshl_add_u32 v253, v253, 2, s77
W_poll_35:
    global_load_dword v254, v253, s[70:71] sc1
    s_waitcnt vmcnt(0)
    v_cmp_ne_u32 vcc, s68, v254
    s_cmp_eq_u64 vcc, 0
    s_cbranch_scc1 W_ok_36
    s_sleep 3
    s_branch W_poll_35
W_ok_36:
W_end_30:
    s_barrier
    v_and_b32 v1, 15, v0
    v_bfe_u32 v2, v0, 4, 2
    v_lshrrev_b32 v3, 6, v0
    s_lshr_b32 s6, s2, 4
    s_lshl_b32 s6, s6, 10
    s_lshr_b32 s7, s2, 2
    s_and_b32 s7, s7, 3
    s_lshl_b32 s7, s7, 8
    s_add_u32 s6, s6, s7
    s_and_b32 s7, s2, 3
    s_lshl_b32 s7, s7, 2
    s_add_u32 s6, s6, s7
    s_add_u32 s6, s64, s6
    s_addc_u32 s7, s65, 0
    v_lshrrev_b32 v4, 4, v0
    v_mul_u32_u24 v4, 14336, v4
    v_lshl_add_u32 v4, v1, 4, v4
    global_load_dword v190, v4, s[6:7] sc1
    v_add_u32 v4, 229376, v4
    global_load_dword v191, v4, s[6:7] sc1
    v_add_u32 v4, 229376, v4
    global_load_dword v192, v4, s[6:7] sc1
    v_add_u32 v4, 229376, v4
    global_load_dword v193, v4, s[6:7] sc1
    v_add_u32 v4, 229376, v4
    global_load_dword v194, v4, s[6:7] sc1
    v_add_u32 v4, 229376, v4
    global_load_dword v195, v4, s[6:7] sc1
    v_add_u32 v4, 229376, v4
    global_load_dword v196, v4, s[6:7] sc1
    v_add_u32 v4, 229376, v4
    global_load_dword v197, v4, s[6:7] sc1
    s_branch B_kloop
B_kdone:
    s_setprio 3
    v_and_b32 v1, 15, v0
    v_bfe_u32 v2, v0, 4, 2
    v_lshrrev_b32 v3, 6, v0
    v_lshlrev_b32 v5, 1, v0
    v_cmp_gt_u32 vcc, 16, v0
    s_and_saveexec_b64 s[18:19], vcc
    v_mov_b32 v8, 0
    ds_write_b16 v5, v8 offset:18432
    ds_write_b16 v5, v8 offset:22592
    ds_write_b16 v5, v8 offset:26752
    ds_write_b16 v5, v8 offset:30912
    s_mov_b64 exec, s[18:19]
    s_waitcnt lgkmcnt(0)
    s_barrier
    s_waitcnt vmcnt(7)
    ds_write_b16 v5, v190 offset:18464
    ds_write_b16 v5, v190 offset:22622
    ds_write_b16_d16_hi v5, v190 offset:26784
    ds_write_b16_d16_hi v5, v190 offset:30942
    s_waitcnt vmcnt(6)
    ds_write_b16 v5, v191 offset:18976
    ds_write_b16 v5, v191 offset:23134
    ds_write_b16_d16_hi v5, v191 offset:27296
    ds_write_b16_d16_hi v5, v191 offset:31454
    s_waitcnt vmcnt(5)
    ds_write_b16 v5, v192 offset:19488
    ds_write_b16 v5, v192 offset:23646
    ds_write_b16_d16_hi v5, v192 offset:27808
    ds_write_b16_d16_hi v5, v192 offset:31966
    s_waitcnt vmcnt(4)
    ds_write_b16 v5, v193 offset:20000
    ds_write_b16 v5, v193 offset:24158
    ds_write_b16_d16_hi v5, v193 offset:28320
    ds_write_b16_d16_hi v5, v193 offset:32478
    s_waitcnt vmcnt(3)
    ds_write_b16 v5, v194 offset:20512
    ds_write_b16 v5, v194 offset:24670
    ds_write_b16_d16_hi v5, v194 offset:28832
    ds_write_b16_d16_hi v5, v194 offset:32990
    s_waitcnt vmcnt(2)
    ds_write_b16 v5, v195 offset:21024
    ds_write_b16 v5, v195 offset:25182
    ds_write_b16_d16_hi v5, v195 offset:29344
    ds_write_b16_d16_hi v5, v195 offset:33502
    s_waitcnt vmcnt(1)
    ds_write_b16 v5, v196 offset:21536
    ds_write_b16 v5, v196 offset:25694
    ds_write_b16_d16_hi v5, v196 offset:29856
    ds_write_b16_d16_hi v5, v196 offset:34014
    s_waitcnt vmcnt(0)
    ds_write_b16 v5, v197 offset:22048
    ds_write_b16 v5, v197 offset:26206
    ds_write_b16_d16_hi v5, v197 offset:30368
    ds_write_b16_d16_hi v5, v197 offset:34526
    s_waitcnt lgkmcnt(0)
    s_barrier
    v_lshrrev_b32 v4, 1, v3
    v_lshl_add_u32 v5, v2, 3, v1
    v_add_u32 v5, 1, v5
    v_and_b32 v7, 1, v5
    v_sub_u32 v5, v5, v7
    v_lshlrev_b32 v5, 1, v5
    v_mul_u32_u24 v7, 4160, v7
    v_add_u32 v5, v5, v7
    v_mul_u32_u24 v7, 8320, v4
    v_add_u32 v5, v5, v7
    v_and_b32 v7, 1, v3
    v_lshl_add_u32 v5, v7, 8, v5
    v_add_u32 v232, 18432, v5
    v_add_u32 v233, 512, v232
    v_add_u32 v234, 1024, v232
    v_add_u32 v235, 1536, v232
    v_add_u32 v236, 2048, v232
    v_add_u32 v237, 2560, v232
    v_add_u32 v238, 3072, v232
    v_add_u32 v239, 3584, v232
    v_mul_u32_u24 v6, 9216, v4
    v_lshl_add_u32 v6, v2, 4, v6
    v_lshl_add_u32 v6, v7, 8, v6
    v_lshlrev_b32 v7, 5, v1
    v_sub_u32 v6, v6, v7
    v_add_u32 v6, 480, v6
    ds_read2_b32 v[40:41], v232 offset0:0 offset1:1
    ds_read2_b32 v[42:43], v232 offset0:2 offset1:3
    ds_read2_b32 v[44:45], v233 offset0:0 offset1:1
    ds_read2_b32 v[46:47], v233 offset0:2 offset1:3
    ds_read2_b32 v[48:49], v234 offset0:0 offset1:1
    ds_read2_b32 v[50:51], v234 offset0:2 offset1:3
    ds_read2_b32 v[52:53], v235 offset0:0 offset1:1
    ds_read2_b32 v[54:55], v235 offset0:2 offset1:3
    ds_read2_b32 v[56:57], v236 offset0:0 offset1:1
    ds_read2_b32 v[58:59], v236 offset0:2 offset1:3
    ds_read2_b32 v[60:61], v237 offset0:0 offset1:1
    ds_read2_b32 v[62:63], v237 offset0:2 offset1:3
    ds_read2_b32 v[64:65], v238 offset0:0 offset1:1
    ds_read2_b32 v[66:67], v238 offset0:2 offset1:3
    ds_read2_b32 v[68:69], v239 offset0:0 offset1:1
    ds_read2_b32 v[70:71], v239 offset0:2 offset1:3
    ds_read_b128 v[72:75], v6 offset:3584
    ds_read_b128 v[76:79], v6 offset:8192
    ds_read_b128 v[80:83], v6 offset:3072
    ds_read_b128 v[84:87], v6 offset:7680
    ds_read_b128 v[88:91], v6 offset:2560
    ds_read_b128 v[92:95], v6 offset:7168
    ds_read_b128 v[96:99], v6 offset:2048
    ds_read_b128 v[100:103], v6 offset:6656
    ds_read_b128 v[104:107], v6 offset:1536
    ds_read_b128 v[108:111], v6 offset:6144
    ds_read_b128 v[112:115], v6 offset:1024
    ds_read_b128 v[116:119], v6 offset:5632
    ds_read_b128 v[120:123], v6 offset:512
    ds_read_b128 v[124:127], v6 offset:5120
    ds_read_b128 v[128:131], v6 offset:0
    ds_read_b128 v[132:135], v6 offset:4608
    s_waitcnt lgkmcnt(0)
    v_mfma_f32_16x16x32_bf16 v[8:11], v[40:43], v[72:75], 0
    v_mfma_f32_16x16x32_bf16 v[8:11], v[40:43], v[76:79], v[8:11]
    ds_read2_b32 v[136:137], v232 offset0:16 offset1:17
    v_mfma_f32_16x16x32_bf16 v[12:15], v[40:43], v[80:83], 0
    v_mfma_f32_16x16x32_bf16 v[12:15], v[40:43], v[84:87], v[12:15]
    ds_read2_b32 v[138:139], v232 offset0:18 offset1:19
    v_mfma_f32_16x16x32_bf16 v[12:15], v[44:47], v[72:75], v[12:15]
    v_mfma_f32_16x16x32_bf16 v[12:15], v[44:47], v[76:79], v[12:15]
    ds_read2_b32 v[140:141], v233 offset0:16 offset1:17
    v_mfma_f32_16x16x32_bf16 v[16:19], v[40:43], v[88:91], 0
    v_mfma_f32_16x16x32_bf16 v[16:19], v[40:43], v[92:95], v[16:19]
    ds_read2_b32 v[142:143], v233 offset0:18 offset1:19
    v_mfma_f32_16x16x32_bf16 v[16:19], v[44:47], v[80:83], v[16:19]
    v_mfma_f32_16x16x32_bf16 v[16:19], v[44:47], v[84:87], v[16:19]
    ds_read2_b32 v[144:145], v234 offset0:16 offset1:17
    v_mfma_f32_16x16x32_bf16 v[16:19], v[48:51], v[72:75], v[16:19]
    v_mfma_f32_16x16x32_bf16 v[16:19], v[48:51], v[76:79], v[16:19]
    ds_read2_b32 v[146:147], v234 offset0:18 offset1:19
    v_mfma_f32_16x16x32_bf16 v[20:23], v[40:43], v[96:99], 0
    v_mfma_f32_16x16x32_bf16 v[20:23], v[40:43], v[100:103], v[20:23]
    ds_read2_b32 v[148:149], v235 offset0:16 offset1:17
    v_mfma_f32_16x16x32_bf16 v[20:23], v[44:47], v[88:91], v[20:23]
    v_mfma_f32_16x16x32_bf16 v[20:23], v[44:47], v[92:95], v[20:23]
    ds_read2_b32 v[150:151], v235 offset0:18 offset1:19
    v_mfma_f32_16x16x32_bf16 v[20:23], v[48:51], v[80:83], v[20:23]
    v_mfma_f32_16x16x32_bf16 v[20:23], v[48:51], v[84:87], v[20:23]
    ds_read2_b32 v[152:153], v236 offset0:16 offset1:17
    v_mfma_f32_16x16x32_bf16 v[20:23], v[52:55], v[72:75], v[20:23]
    v_mfma_f32_16x16x32_bf16 v[20:23], v[52:55], v[76:79], v[20:23]
    ds_read2_b32 v[154:155], v236 offset0:18 offset1:19
    v_mfma_f32_16x16x32_bf16 v[24:27], v[40:43], v[104:107], 0
    v_mfma_f32_16x16x32_bf16 v[24:27], v[40:43], v[108:111], v[24:27]
    ds_read2_b32 v[156:157], v237 offset0:16 offset1:17
    v_mfma_f32_16x16x32_bf16 v[24:27], v[44:47], v[96:99], v[24:27]
    v_mfma_f32_16x16x32_bf16 v[24:27], v[44:47], v[100:103], v[24:27]
    ds_read2_b32 v[158:159], v237 offset0:18 offset1:19
    v_mfma_f32_16x16x32_bf16 v[24:27], v[48:51], v[88:91], v[24:27]
    v_mfma_f32_16x16x32_bf16 v[24:27], v[48:51], v[92:95], v[24:27]
    ds_read2_b32 v[160:161], v238 offset0:16 offset1:17
    v_mfma_f32_16x16x32_bf16 v[24:27], v[52:55], v[80:83], v[24:27]
    v_mfma_f32_16x16x32_bf16 v[24:27], v[52:55], v[84:87], v[24:27]
    ds_read2_b32 v[162:163], v238 offset0:18 offset1:19
    v_mfma_f32_16x16x32_bf16 v[24:27], v[56:59], v[72:75], v[24:27]
    v_mfma_f32_16x16x32_bf16 v[24:27], v[56:59], v[76:79], v[24:27]
    ds_read2_b32 v[164:165], v239 offset0:16 offset1:17
    v_mfma_f32_16x16x32_bf16 v[28:31], v[40:43], v[112:115], 0
    v_mfma_f32_16x16x32_bf16 v[28:31], v[40:43], v[116:119], v[28:31]
    ds_read2_b32 v[166:167], v239 offset0:18 offset1:19
    v_mfma_f32_16x16x32_bf16 v[28:31], v[44:47], v[104:107], v[28:31]
    v_mfma_f32_16x16x32_bf16 v[28:31], v[44:47], v[108:111], v[28:31]
    ds_read_b128 v[168:171], v6 offset:3648
    v_mfma_f32_16x16x32_bf16 v[28:31], v[48:51], v[96:99], v[28:31]
    v_mfma_f32_16x16x32_bf16 v[28:31], v[48:51], v[100:103], v[28:31]
    ds_read_b128 v[172:175], v6 offset:8256
    v_mfma_f32_16x16x32_bf16 v[28:31], v[52:55], v[88:91], v[28:31]
    v_mfma_f32_16x16x32_bf16 v[28:31], v[52:55], v[92:95], v[28:31]
    ds_read_b128 v[176:179], v6 offset:3136
    v_mfma_f32_16x16x32_bf16 v[28:31], v[56:59], v[80:83], v[28:31]
    v_mfma_f32_16x16x32_bf16 v[28:31], v[56:59], v[84:87], v[28:31]
    ds_read_b128 v[180:183], v6 offset:7744
    v_mfma_f32_16x16x32_bf16 v[28:31], v[60:63], v[72:75], v[28:31]
    v_mfma_f32_16x16x32_bf16 v[28:31], v[60:63], v[76:79], v[28:31]
    ds_read_b128 v[184:187], v6 offset:2624
    v_mfma_f32_16x16x32_bf16 v[32:35], v[40:43], v[120:123], 0
    v_mfma_f32_16x16x32_bf16 v[32:35], v[40:43], v[124:127], v[32:35]
    ds_read_b128 v[188:191], v6 offset:7232
    v_mfma_f32_16x16x32_bf16 v[32:35], v[44:47], v[112:115], v[32:35]
    v_mfma_f32_16x16x32_bf16 v[32:35], v[44:47], v[116:119], v[32:35]
    ds_read_b128 v[192:195], v6 offset:2112
    v_mfma_f32_16x16x32_bf16 v[32:35], v[48:51], v[104:107], v[32:35]
    v_mfma_f32_16x16x32_bf16 v[32:35], v[48:51], v[108:111], v[32:35]
    ds_read_b128 v[196:199], v6 offset:6720
    v_mfma_f32_16x16x32_bf16 v[32:35], v[52:55], v[96:99], v[32:35]
    v_mfma_f32_16x16x32_bf16 v[32:35], v[52:55], v[100:103], v[32:35]
    ds_read_b128 v[200:203], v6 offset:1600
    v_mfma_f32_16x16x32_bf16 v[32:35], v[56:59], v[88:91], v[32:35]
    v_mfma_f32_16x16x32_bf16 v[32:35], v[56:59], v[92:95], v[32:35]
    ds_read_b128 v[204:207], v6 offset:6208
    v_mfma_f32_16x16x32_bf16 v[32:35], v[60:63], v[80:83], v[32:35]
    v_mfma_f32_16x16x32_bf16 v[32:35], v[60:63], v[84:87], v[32:35]
    ds_read_b128 v[208:211], v6 offset:1088
    v_mfma_f32_16x16x32_bf16 v[32:35], v[64:67], v[72:75], v[32:35]
    v_mfma_f32_16x16x32_bf16 v[32:35], v[64:67], v[76:79], v[32:35]
    ds_read_b128 v[212:215], v6 offset:5696
    v_mfma_f32_16x16x32_bf16 v[36:39], v[40:43], v[128:131], 0
    v_mfma_f32_16x16x32_bf16 v[36:39], v[40:43], v[132:135], v[36:39]
    ds_read_b128 v[216:219], v6 offset:576
    v_mfma_f32_16x16x32_bf16 v[36:39], v[44:47], v[120:123], v[36:39]
    v_mfma_f32_16x16x32_bf16 v[36:39], v[44:47], v[124:127], v[36:39]
    ds_read_b128 v[220:223], v6 offset:5184
    v_mfma_f32_16x16x32_bf16 v[36:39], v[48:51], v[112:115], v[36:39]
    v_mfma_f32_16x16x32_bf16 v[36:39], v[48:51], v[116:119], v[36:39]
    ds_read_b128 v[224:227], v6 offset:64
    v_mfma_f32_16x16x32_bf16 v[36:39], v[52:55], v[104:107], v[36:39]
    v_mfma_f32_16x16x32_bf16 v[36:39], v[52:55], v[108:111], v[36:39]
    ds_read_b128 v[228:231], v6 offset:4672
    v_mfma_f32_16x16x32_bf16 v[36:39], v[56:59], v[96:99], v[36:39]
    v_mfma_f32_16x16x32_bf16 v[36:39], v[56:59], v[100:103], v[36:39]
    v_mfma_f32_16x16x32_bf16 v[36:39], v[60:63], v[88:91], v[36:39]
    v_mfma_f32_16x16x32_bf16 v[36:39], v[60:63], v[92:95], v[36:39]
    v_mfma_f32_16x16x32_bf16 v[36:39], v[64:67], v[80:83], v[36:39]
    v_mfma_f32_16x16x32_bf16 v[36:39], v[64:67], v[84:87], v[36:39]
    v_mfma_f32_16x16x32_bf16 v[36:39], v[68:71], v[72:75], v[36:39]
    v_mfma_f32_16x16x32_bf16 v[36:39], v[68:71], v[76:79], v[36:39]
    s_waitcnt lgkmcnt(0)
    v_mfma_f32_16x16x32_bf16 v[8:11], v[136:139], v[168:171], v[8:11]
    v_mfma_f32_16x16x32_bf16 v[8:11], v[136:139], v[172:175], v[8:11]
    ds_read2_b32 v[40:41], v232 offset0:32 offset1:33
    v_mfma_f32_16x16x32_bf16 v[12:15], v[136:139], v[176:179], v[12:15]
    v_mfma_f32_16x16x32_bf16 v[12:15], v[136:139], v[180:183], v[12:15]
    ds_read2_b32 v[42:43], v232 offset0:34 offset1:35
    v_mfma_f32_16x16x32_bf16 v[12:15], v[140:143], v[168:171], v[12:15]
    v_mfma_f32_16x16x32_bf16 v[12:15], v[140:143], v[172:175], v[12:15]
    ds_read2_b32 v[44:45], v233 offset0:32 offset1:33
    v_mfma_f32_16x16x32_bf16 v[16:19], v[136:139], v[184:187], v[16:19]
    v_mfma_f32_16x16x32_bf16 v[16:19], v[136:139], v[188:191], v[16:19]
    ds_read2_b32 v[46:47], v233 offset0:34 offset1:35
    v_mfma_f32_16x16x32_bf16 v[16:19], v[140:143], v[176:179], v[16:19]
    v_mfma_f32_16x16x32_bf16 v[16:19], v[140:143], v[180:183], v[16:19]
    ds_read2_b32 v[48:49], v234 offset0:32 offset1:33
    v_mfma_f32_16x16x32_bf16 v[16:19], v[144:147], v[168:171], v[16:19]
    v_mfma_f32_16x16x32_bf16 v[16:19], v[144:147], v[172:175], v[16:19]
    ds_read2_b32 v[50:51], v234 offset0:34 offset1:35
    v_mfma_f32_16x16x32_bf16 v[20:23], v[136:139], v[192:195], v[20:23]
    v_mfma_f32_16x16x32_bf16 v[20:23], v[136:139], v[196:199], v[20:23]
    ds_read2_b32 v[52:53], v235 offset0:32 offset1:33
    v_mfma_f32_16x16x32_bf16 v[20:23], v[140:143], v[184:187], v[20:23]
    v_mfma_f32_16x16x32_bf16 v[20:23], v[140:143], v[188:191], v[20:23]
    ds_read2_b32 v[54:55], v235 offset0:34 offset1:35
    v_mfma_f32_16x16x32_bf16 v[20:23], v[144:147], v[176:179], v[20:23]
    v_mfma_f32_16x16x32_bf16 v[20:23], v[144:147], v[180:183], v[20:23]
    ds_read2_b32 v[56:57], v236 offset0:32 offset1:33
    v_mfma_f32_16x16x32_bf16 v[20:23], v[148:151], v[168:171], v[20:23]
    v_mfma_f32_16x16x32_bf16 v[20:23], v[148:151], v[172:175], v[20:23]
    ds_read2_b32 v[58:59], v236 offset0:34 offset1:35
    v_mfma_f32_16x16x32_bf16 v[24:27], v[136:139], v[200:203], v[24:27]
    v_mfma_f32_16x16x32_bf16 v[24:27], v[136:139], v[204:207], v[24:27]
    ds_read2_b32 v[60:61], v237 offset0:32 offset1:33
    v_mfma_f32_16x16x32_bf16 v[24:27], v[140:143], v[192:195], v[24:27]
    v_mfma_f32_16x16x32_bf16 v[24:27], v[140:143], v[196:199], v[24:27]
    ds_read2_b32 v[62:63], v237 offset0:34 offset1:35
    v_mfma_f32_16x16x32_bf16 v[24:27], v[144:147], v[184:187], v[24:27]
    v_mfma_f32_16x16x32_bf16 v[24:27], v[144:147], v[188:191], v[24:27]
    ds_read2_b32 v[64:65], v238 offset0:32 offset1:33
    v_mfma_f32_16x16x32_bf16 v[24:27], v[148:151], v[176:179], v[24:27]
    v_mfma_f32_16x16x32_bf16 v[24:27], v[148:151], v[180:183], v[24:27]
    ds_read2_b32 v[66:67], v238 offset0:34 offset1:35
    v_mfma_f32_16x16x32_bf16 v[24:27], v[152:155], v[168:171], v[24:27]
    v_mfma_f32_16x16x32_bf16 v[24:27], v[152:155], v[172:175], v[24:27]
    ds_read2_b32 v[68:69], v239 offset0:32 offset1:33
    v_mfma_f32_16x16x32_bf16 v[28:31], v[136:139], v[208:211], v[28:31]
    v_mfma_f32_16x16x32_bf16 v[28:31], v[136:139], v[212:215], v[28:31]
    ds_read2_b32 v[70:71], v239 offset0:34 offset1:35
    v_mfma_f32_16x16x32_bf16 v[28:31], v[140:143], v[200:203], v[28:31]
    v_mfma_f32_16x16x32_bf16 v[28:31], v[140:143], v[204:207], v[28:31]
    ds_read_b128 v[72:75], v6 offset:3712
    v_mfma_f32_16x16x32_bf16 v[28:31], v[144:147], v[192:195], v[28:31]
    v_mfma_f32_16x16x32_bf16 v[28:31], v[144:147], v[196:199], v[28:31]
    ds_read_b128 v[76:79], v6 offset:8320
    v_mfma_f32_16x16x32_bf16 v[28:31], v[148:151], v[184:187], v[28:31]
    v_mfma_f32_16x16x32_bf16 v[28:31], v[148:151], v[188:191], v[28:31]
    ds_read_b128 v[80:83], v6 offset:3200
    v_mfma_f32_16x16x32_bf16 v[28:31], v[152:155], v[176:179], v[28:31]
    v_mfma_f32_16x16x32_bf16 v[28:31], v[152:155], v[180:183], v[28:31]
    ds_read_b128 v[84:87], v6 offset:7808
    v_mfma_f32_16x16x32_bf16 v[28:31], v[156:159], v[168:171], v[28:31]
    v_mfma_f32_16x16x32_bf16 v[28:31], v[156:159], v[172:175], v[28:31]
    ds_read_b128 v[88:91], v6 offset:2688
    v_mfma_f32_16x16x32_bf16 v[32:35], v[136:139], v[216:219], v[32:35]
    v_mfma_f32_16x16x32_bf16 v[32:35], v[136:139], v[220:223], v[32:35]
    ds_read_b128 v[92:95], v6 offset:7296
    v_mfma_f32_16x16x32_bf16 v[32:35], v[140:143], v[208:211], v[32:35]
    v_mfma_f32_16x16x32_bf16 v[32:35], v[140:143], v[212:215], v[32:35]
    ds_read_b128 v[96:99], v6 offset:2176
    v_mfma_f32_16x16x32_bf16 v[32:35], v[144:147], v[200:203], v[32:35]
    v_mfma_f32_16x16x32_bf16 v[32:35], v[144:147], v[204:207], v[32:35]
    ds_read_b128 v[100:103], v6 offset:6784
    v_mfma_f32_16x16x32_bf16 v[32:35], v[148:151], v[192:195], v[32:35]
    v_mfma_f32_16x16x32_bf16 v[32:35], v[148:151], v[196:199], v[32:35]
    ds_read_b128 v[104:107], v6 offset:1664
    v_mfma_f32_16x16x32_bf16 v[32:35], v[152:155], v[184:187], v[32:35]
    v_mfma_f32_16x16x32_bf16 v[32:35], v[152:155], v[188:191], v[32:35]
    ds_read_b128 v[108:111], v6 offset:6272
    v_mfma_f32_16x16x32_bf16 v[32:35], v[156:159], v[176:179], v[32:35]
    v_mfma_f32_16x16x32_bf16 v[32:35], v[156:159], v[180:183], v[32:35]
    ds_read_b128 v[112:115], v6 offset:1152
    v_mfma_f32_16x16x32_bf16 v[32:35], v[160:163], v[168:171], v[32:35]
    v_mfma_f32_16x16x32_bf16 v[32:35], v[160:163], v[172:175], v[32:35]
    ds_read_b128 v[116:119], v6 offset:5760
    v_mfma_f32_16x16x32_bf16 v[36:39], v[136:139], v[224:227], v[36:39]
    v_mfma_f32_16x16x32_bf16 v[36:39], v[136:139], v[228:231], v[36:39]
    ds_read_b128 v[120:123], v6 offset:640
    v_mfma_f32_16x16x32_bf16 v[36:39], v[140:143], v[216:219], v[36:39]
    v_mfma_f32_16x16x32_bf16 v[36:39], v[140:143], v[220:223], v[36:39]
    ds_read_b128 v[124:127], v6 offset:5248
    v_mfma_f32_16x16x32_bf16 v[36:39], v[144:147], v[208:211], v[36:39]
    v_mfma_f32_16x16x32_bf16 v[36:39], v[144:147], v[212:215], v[36:39]
    ds_read_b128 v[128:131], v6 offset:128
    v_mfma_f32_16x16x32_bf16 v[36:39], v[148:151], v[200:203], v[36:39]
    v_mfma_f32_16x16x32_bf16 v[36:39], v[148:151], v[204:207], v[36:39]
    ds_read_b128 v[132:135], v6 offset:4736
    v_mfma_f32_16x16x32_bf16 v[36:39], v[152:155], v[192:195], v[36:39]
    v_mfma_f32_16x16x32_bf16 v[36:39], v[152:155], v[196:199], v[36:39]
    v_mfma_f32_16x16x32_bf16 v[36:39], v[156:159], v[184:187], v[36:39]
    v_mfma_f32_16x16x32_bf16 v[36:39], v[156:159], v[188:191], v[36:39]
    v_mfma_f32_16x16x32_bf16 v[36:39], v[160:163], v[176:179], v[36:39]
    v_mfma_f32_16x16x32_bf16 v[36:39], v[160:163], v[180:183], v[36:39]
    v_mfma_f32_16x16x32_bf16 v[36:39], v[164:167], v[168:171], v[36:39]
    v_mfma_f32_16x16x32_bf16 v[36:39], v[164:167], v[172:175], v[36:39]
    s_waitcnt lgkmcnt(0)
    v_mfma_f32_16x16x32_bf16 v[8:11], v[40:43], v[72:75], v[8:11]
    v_mfma_f32_16x16x32_bf16 v[8:11], v[40:43], v[76:79], v[8:11]
    ds_read2_b32 v[136:137], v232 offset0:48 offset1:49
    v_mfma_f32_16x16x32_bf16 v[12:15], v[40:43], v[80:83], v[12:15]
    v_mfma_f32_16x16x32_bf16 v[12:15], v[40:43], v[84:87], v[12:15]
    ds_read2_b32 v[138:139], v232 offset0:50 offset1:51
    v_mfma_f32_16x16x32_bf16 v[12:15], v[44:47], v[72:75], v[12:15]
    v_mfma_f32_16x16x32_bf16 v[12:15], v[44:47], v[76:79], v[12:15]
    ds_read2_b32 v[140:141], v233 offset0:48 offset1:49
    v_mfma_f32_16x16x32_bf16 v[16:19], v[40:43], v[88:91], v[16:19]
    v_mfma_f32_16x16x32_bf16 v[16:19], v[40:43], v[92:95], v[16:19]
    ds_read2_b32 v[142:143], v233 offset0:50 offset1:51
    v_mfma_f32_16x16x32_bf16 v[16:19], v[44:47], v[80:83], v[16:19]
    v_mfma_f32_16x16x32_bf16 v[16:19], v[44:47], v[84:87], v[16:19]
    ds_read2_b32 v[144:145], v234 offset0:48 offset1:49
    v_mfma_f32_16x16x32_bf16 v[16:19], v[48:51], v[72:75], v[16:19]
    v_mfma_f32_16x16x32_bf16 v[16:19], v[48:51], v[76:79], v[16:19]
    ds_read2_b32 v[146:147], v234 offset0:50 offset1:51
    v_mfma_f32_16x16x32_bf16 v[20:23], v[40:43], v[96:99], v[20:23]
    v_mfma_f32_16x16x32_bf16 v[20:23], v[40:43], v[100:103], v[20:23]
    ds_read2_b32 v[148:149], v235 offset0:48 offset1:49
    v_mfma_f32_16x16x32_bf16 v[20:23], v[44:47], v[88:91], v[20:23]
    v_mfma_f32_16x16x32_bf16 v[20:23], v[44:47], v[92:95], v[20:23]
    ds_read2_b32 v[150:151], v235 offset0:50 offset1:51
    v_mfma_f32_16x16x32_bf16 v[20:23], v[48:51], v[80:83], v[20:23]
    v_mfma_f32_16x16x32_bf16 v[20:23], v[48:51], v[84:87], v[20:23]
    ds_read2_b32 v[152:153], v236 offset0:48 offset1:49
    v_mfma_f32_16x16x32_bf16 v[20:23], v[52:55], v[72:75], v[20:23]
    v_mfma_f32_16x16x32_bf16 v[20:23], v[52:55], v[76:79], v[20:23]
    ds_read2_b32 v[154:155], v236 offset0:50 offset1:51
    v_mfma_f32_16x16x32_bf16 v[24:27], v[40:43], v[104:107], v[24:27]
    v_mfma_f32_16x16x32_bf16 v[24:27], v[40:43], v[108:111], v[24:27]
    ds_read2_b32 v[156:157], v237 offset0:48 offset1:49
    v_mfma_f32_16x16x32_bf16 v[24:27], v[44:47], v[96:99], v[24:27]
    v_mfma_f32_16x16x32_bf16 v[24:27], v[44:47], v[100:103], v[24:27]
    ds_read2_b32 v[158:159], v237 offset0:50 offset1:51
    v_mfma_f32_16x16x32_bf16 v[24:27], v[48:51], v[88:91], v[24:27]
    v_mfma_f32_16x16x32_bf16 v[24:27], v[48:51], v[92:95], v[24:27]
    ds_read2_b32 v[160:161], v238 offset0:48 offset1:49
    v_mfma_f32_16x16x32_bf16 v[24:27], v[52:55], v[80:83], v[24:27]
    v_mfma_f32_16x16x32_bf16 v[24:27], v[52:55], v[84:87], v[24:27]
    ds_read2_b32 v[162:163], v238 offset0:50 offset1:51
    v_mfma_f32_16x16x32_bf16 v[24:27], v[56:59], v[72:75], v[24:27]
    v_mfma_f32_16x16x32_bf16 v[24:27], v[56:59], v[76:79], v[24:27]
    ds_read2_b32 v[164:165], v239 offset0:48 offset1:49
    v_mfma_f32_16x16x32_bf16 v[28:31], v[40:43], v[112:115], v[28:31]
    v_mfma_f32_16x16x32_bf16 v[28:31], v[40:43], v[116:119], v[28:31]
    ds_read2_b32 v[166:167], v239 offset0:50 offset1:51
    v_mfma_f32_16x16x32_bf16 v[28:31], v[44:47], v[104:107], v[28:31]
    v_mfma_f32_16x16x32_bf16 v[28:31], v[44:47], v[108:111], v[28:31]
    ds_read_b128 v[168:171], v6 offset:3776
    v_mfma_f32_16x16x32_bf16 v[28:31], v[48:51], v[96:99], v[28:31]
    v_mfma_f32_16x16x32_bf16 v[28:31], v[48:51], v[100:103], v[28:31]
    ds_read_b128 v[172:175], v6 offset:8384
    v_mfma_f32_16x16x32_bf16 v[28:31], v[52:55], v[88:91], v[28:31]
    v_mfma_f32_16x16x32_bf16 v[28:31], v[52:55], v[92:95], v[28:31]
    ds_read_b128 v[176:179], v6 offset:3264
    v_mfma_f32_16x16x32_bf16 v[28:31], v[56:59], v[80:83], v[28:31]
    v_mfma_f32_16x16x32_bf16 v[28:31], v[56:59], v[84:87], v[28:31]
    ds_read_b128 v[180:183], v6 offset:7872
    v_mfma_f32_16x16x32_bf16 v[28:31], v[60:63], v[72:75], v[28:31]
    v_mfma_f32_16x16x32_bf16 v[28:31], v[60:63], v[76:79], v[28:31]
    ds_read_b128 v[184:187], v6 offset:2752
    v_mfma_f32_16x16x32_bf16 v[32:35], v[40:43], v[120:123], v[32:35]
    v_mfma_f32_16x16x32_bf16 v[32:35], v[40:43], v[124:127], v[32:35]
    ds_read_b128 v[188:191], v6 offset:7360
    v_mfma_f32_16x16x32_bf16 v[32:35], v[44:47], v[112:115], v[32:35]
    v_mfma_f32_16x16x32_bf16 v[32:35], v[44:47], v[116:119], v[32:35]
    ds_read_b128 v[192:195], v6 offset:2240
    v_mfma_f32_16x16x32_bf16 v[32:35], v[48:51], v[104:107], v[32:35]
    v_mfma_f32_16x16x32_bf16 v[32:35], v[48:51], v[108:111], v[32:35]
    ds_read_b128 v[196:199], v6 offset:6848
    v_mfma_f32_16x16x32_bf16 v[32:35], v[52:55], v[96:99], v[32:35]
    v_mfma_f32_16x16x32_bf16 v[32:35], v[52:55], v[100:103], v[32:35]
    ds_read_b128 v[200:203], v6 offset:1728
    v_mfma_f32_16x16x32_bf16 v[32:35], v[56:59], v[88:91], v[32:35]
    v_mfma_f32_16x16x32_bf16 v[32:35], v[56:59], v[92:95], v[32:35]
    ds_read_b128 v[204:207], v6 offset:6336
    v_mfma_f32_16x16x32_bf16 v[32:35], v[60:63], v[80:83], v[32:35]
    v_mfma_f32_16x16x32_bf16 v[32:35], v[60:63], v[84:87], v[32:35]
    ds_read_b128 v[208:211], v6 offset:1216
    v_mfma_f32_16x16x32_bf16 v[32:35], v[64:67], v[72:75], v[32:35]
    v_mfma_f32_16x16x32_bf16 v[32:35], v[64:67], v[76:79], v[32:35]
    ds_read_b128 v[212:215], v6 offset:5824
    v_mfma_f32_16x16x32_bf16 v[36:39], v[40:43], v[128:131], v[36:39]
    v_mfma_f32_16x16x32_bf16 v[36:39], v[40:43], v[132:135], v[36:39]
    ds_read_b128 v[216:219], v6 offset:704
    v_mfma_f32_16x16x32_bf16 v[36:39], v[44:47], v[120:123], v[36:39]
    v_mfma_f32_16x16x32_bf16 v[36:39], v[44:47], v[124:127], v[36:39]
    ds_read_b128 v[220:223], v6 offset:5312
    v_mfma_f32_16x16x32_bf16 v[36:39], v[48:51], v[112:115], v[36:39]
    v_mfma_f32_16x16x32_bf16 v[36:39], v[48:51], v[116:119], v[36:39]
    ds_read_b128 v[224:227], v6 offset:192
    v_mfma_f32_16x16x32_bf16 v[36:39], v[52:55], v[104:107], v[36:39]
    v_mfma_f32_16x16x32_bf16 v[36:39], v[52:55], v[108:111], v[36:39]
    ds_read_b128 v[228:231], v6 offset:4800
    v_mfma_f32_16x16x32_bf16 v[36:39], v[56:59], v[96:99], v[36:39]
    v_mfma_f32_16x16x32_bf16 v[36:39], v[56:59], v[100:103], v[36:39]
    v_mfma_f32_16x16x32_bf16 v[36:39], v[60:63], v[88:91], v[36:39]
    v_mfma_f32_16x16x32_bf16 v[36:39], v[60:63], v[92:95], v[36:39]
    v_mfma_f32_16x16x32_bf16 v[36:39], v[64:67], v[80:83], v[36:39]
    v_mfma_f32_16x16x32_bf16 v[36:39], v[64:67], v[84:87], v[36:39]
    v_mfma_f32_16x16x32_bf16 v[36:39], v[68:71], v[72:75], v[36:39]
    v_mfma_f32_16x16x32_bf16 v[36:39], v[68:71], v[76:79], v[36:39]
    s_waitcnt lgkmcnt(0)
    v_mfma_f32_16x16x32_bf16 v[8:11], v[136:139], v[168:171], v[8:11]
    v_mfma_f32_16x16x32_bf16 v[8:11], v[136:139], v[172:175], v[8:11]
    v_mfma_f32_16x16x32_bf16 v[12:15], v[136:139], v[176:179], v[12:15]
    v_mfma_f32_16x16x32_bf16 v[12:15], v[136:139], v[180:183], v[12:15]
    v_mfma_f32_16x16x32_bf16 v[12:15], v[140:143], v[168:171], v[12:15]
    v_mfma_f32_16x16x32_bf16 v[12:15], v[140:143], v[172:175], v[12:15]
    v_mfma_f32_16x16x32_bf16 v[16:19], v[136:139], v[184:187], v[16:19]
    v_mfma_f32_16x16x32_bf16 v[16:19], v[136:139], v[188:191], v[16:19]
    v_mfma_f32_16x16x32_bf16 v[16:19], v[140:143], v[176:179], v[16:19]
    v_mfma_f32_16x16x32_bf16 v[16:19], v[140:143], v[180:183], v[16:19]
    v_mfma_f32_16x16x32_bf16 v[16:19], v[144:147], v[168:171], v[16:19]
    v_mfma_f32_16x16x32_bf16 v[16:19], v[144:147], v[172:175], v[16:19]
    v_mfma_f32_16x16x32_bf16 v[20:23], v[136:139], v[192:195], v[20:23]
    v_mfma_f32_16x16x32_bf16 v[20:23], v[136:139], v[196:199], v[20:23]
    v_mfma_f32_16x16x32_bf16 v[20:23], v[140:143], v[184:187], v[20:23]
    v_mfma_f32_16x16x32_bf16 v[20:23], v[140:143], v[188:191], v[20:23]
    v_mfma_f32_16x16x32_bf16 v[20:23], v[144:147], v[176:179], v[20:23]
    v_mfma_f32_16x16x32_bf16 v[20:23], v[144:147], v[180:183], v[20:23]
    v_mfma_f32_16x16x32_bf16 v[20:23], v[148:151], v[168:171], v[20:23]
    v_mfma_f32_16x16x32_bf16 v[20:23], v[148:151], v[172:175], v[20:23]
    v_mfma_f32_16x16x32_bf16 v[24:27], v[136:139], v[200:203], v[24:27]
    v_mfma_f32_16x16x32_bf16 v[24:27], v[136:139], v[204:207], v[24:27]
    v_mfma_f32_16x16x32_bf16 v[24:27], v[140:143], v[192:195], v[24:27]
    v_mfma_f32_16x16x32_bf16 v[24:27], v[140:143], v[196:199], v[24:27]
    v_mfma_f32_16x16x32_bf16 v[24:27], v[144:147], v[184:187], v[24:27]
    v_mfma_f32_16x16x32_bf16 v[24:27], v[144:147], v[188:191], v[24:27]
    v_mfma_f32_16x16x32_bf16 v[24:27], v[148:151], v[176:179], v[24:27]
    v_mfma_f32_16x16x32_bf16 v[24:27], v[148:151], v[180:183], v[24:27]
    v_mfma_f32_16x16x32_bf16 v[24:27], v[152:155], v[168:171], v[24:27]
    v_mfma_f32_16x16x32_bf16 v[24:27], v[152:155], v[172:175], v[24:27]
    v_mfma_f32_16x16x32_bf16 v[28:31], v[136:139], v[208:211], v[28:31]
    v_mfma_f32_16x16x32_bf16 v[28:31], v[136:139], v[212:215], v[28:31]
    v_mfma_f32_16x16x32_bf16 v[28:31], v[140:143], v[200:203], v[28:31]
    v_mfma_f32_16x16x32_bf16 v[28:31], v[140:143], v[204:207], v[28:31]
    v_mfma_f32_16x16x32_bf16 v[28:31], v[144:147], v[192:195], v[28:31]
    v_mfma_f32_16x16x32_bf16 v[28:31], v[144:147], v[196:199], v[28:31]
    v_mfma_f32_16x16x32_bf16 v[28:31], v[148:151], v[184:187], v[28:31]
    v_mfma_f32_16x16x32_bf16 v[28:31], v[148:151], v[188:191], v[28:31]
    v_mfma_f32_16x16x32_bf16 v[28:31], v[152:155], v[176:179], v[28:31]
    v_mfma_f32_16x16x32_bf16 v[28:31], v[152:155], v[180:183], v[28:31]
    v_mfma_f32_16x16x32_bf16 v[28:31], v[156:159], v[168:171], v[28:31]
    v_mfma_f32_16x16x32_bf16 v[28:31], v[156:159], v[172:175], v[28:31]
    v_mfma_f32_16x16x32_bf16 v[32:35], v[136:139], v[216:219], v[32:35]
    v_mfma_f32_16x16x32_bf16 v[32:35], v[136:139], v[220:223], v[32:35]
    v_mfma_f32_16x16x32_bf16 v[32:35], v[140:143], v[208:211], v[32:35]
    v_mfma_f32_16x16x32_bf16 v[32:35], v[140:143], v[212:215], v[32:35]
    v_mfma_f32_16x16x32_bf16 v[32:35], v[144:147], v[200:203], v[32:35]
    v_mfma_f32_16x16x32_bf16 v[32:35], v[144:147], v[204:207], v[32:35]
    v_mfma_f32_16x16x32_bf16 v[32:35], v[148:151], v[192:195], v[32:35]
    v_mfma_f32_16x16x32_bf16 v[32:35], v[148:151], v[196:199], v[32:35]
    v_mfma_f32_16x16x32_bf16 v[32:35], v[152:155], v[184:187], v[32:35]
    v_mfma_f32_16x16x32_bf16 v[32:35], v[152:155], v[188:191], v[32:35]
    v_mfma_f32_16x16x32_bf16 v[32:35], v[156:159], v[176:179], v[32:35]
    v_mfma_f32_16x16x32_bf16 v[32:35], v[156:159], v[180:183], v[32:35]
    v_mfma_f32_16x16x32_bf16 v[32:35], v[160:163], v[168:171], v[32:35]
    v_mfma_f32_16x16x32_bf16 v[32:35], v[160:163], v[172:175], v[32:35]
    v_mfma_f32_16x16x32_bf16 v[36:39], v[136:139], v[224:227], v[36:39]
    v_mfma_f32_16x16x32_bf16 v[36:39], v[136:139], v[228:231], v[36:39]
    v_mfma_f32_16x16x32_bf16 v[36:39], v[140:143], v[216:219], v[36:39]
    v_mfma_f32_16x16x32_bf16 v[36:39], v[140:143], v[220:223], v[36:39]
    v_mfma_f32_16x16x32_bf16 v[36:39], v[144:147], v[208:211], v[36:39]
    v_mfma_f32_16x16x32_bf16 v[36:39], v[144:147], v[212:215], v[36:39]
    v_mfma_f32_16x16x32_bf16 v[36:39], v[148:151], v[200:203], v[36:39]
    v_mfma_f32_16x16x32_bf16 v[36:39], v[148:151], v[204:207], v[36:39]
    v_mfma_f32_16x16x32_bf16 v[36:39], v[152:155], v[192:195], v[36:39]
    v_mfma_f32_16x16x32_bf16 v[36:39], v[152:155], v[196:199], v[36:39]
    v_mfma_f32_16x16x32_bf16 v[36:39], v[156:159], v[184:187], v[36:39]
    v_mfma_f32_16x16x32_bf16 v[36:39], v[156:159], v[188:191], v[36:39]
    v_mfma_f32_16x16x32_bf16 v[36:39], v[160:163], v[176:179], v[36:39]
    v_mfma_f32_16x16x32_bf16 v[36:39], v[160:163], v[180:183], v[36:39]
    v_mfma_f32_16x16x32_bf16 v[36:39], v[164:167], v[168:171], v[36:39]
    v_mfma_f32_16x16x32_bf16 v[36:39], v[164:167], v[172:175], v[36:39]
    s_barrier
    v_and_b32 v5, 63, v0
    v_lshlrev_b32 v5, 4, v5
    v_lshl_add_u32 v6, v3, 12, v5
    v_xor_b32 v7, 1, v3
    v_lshl_add_u32 v5, v7, 12, v5
    s_lshl_b32 s10, s2, 13
    s_add_u32 s10, s10, 25165824
    s_add_u32 s10, s64, s10
    s_addc_u32 s11, s65, 0
    v_lshlrev_b32 v7, 12, v4
    v_lshl_add_u32 v7, v1, 5, v7
    v_lshl_add_u32 v7, v2, 3, v7
    s_lshl_b32 s74, s2, 2
    s_add_u32 s74, s74, 4096
    s_and_b32 s9, s69, 1
    s_cmp_eq_u32 s9, 1
    s_cbranch_scc1 B_cv1
    ds_write_b128 v6, v[24:27] offset:0
    ds_write_b128 v6, v[28:31] offset:1024
    ds_write_b128 v6, v[32:35] offset:2048
    ds_write_b128 v6, v[36:39] offset:3072
    s_waitcnt lgkmcnt(0)
    s_barrier
    ds_read_b128 v[40:43], v5 offset:0
    ds_read_b128 v[44:47], v5 offset:1024
    ds_read_b128 v[48:51], v5 offset:2048
    ds_read_b128 v[52:55], v5 offset:3072
    s_waitcnt lgkmcnt(0)
    v_add_f32 v8, v8, v40
    v_add_f32 v9, v9, v41
    v_add_f32 v10, v10, v42
    v_add_f32 v11, v11, v43
    v_cvt_pk_bf16_f32 v56, v8, v9
    v_cvt_pk_bf16_f32 v57, v10, v11
    global_store_dwordx2 v7, v[56:57], s[10:11] offset:0 sc1
    v_add_f32 v12, v12, v44
    v_add_f32 v13, v13, v45
    v_add_f32 v14, v14, v46
    v_add_f32 v15, v15, v47
    v_cvt_pk_bf16_f32 v58, v12, v13
    v_cvt_pk_bf16_f32 v59, v14, v15
    global_store_dwordx2 v7, v[58:59], s[10:11] offset:512 sc1
    v_add_f32 v16, v16, v48
    v_add_f32 v17, v17, v49
    v_add_f32 v18, v18, v50
    v_add_f32 v19, v19, v51
    v_cvt_pk_bf16_f32 v60, v16, v17
    v_cvt_pk_bf16_f32 v61, v18, v19
    global_store_dwordx2 v7, v[60:61], s[10:11] offset:1024 sc1
    v_add_f32 v20, v20, v52
    v_add_f32 v21, v21, v53
    v_add_f32 v22, v22, v54
    v_add_f32 v23, v23, v55
    v_cvt_pk_bf16_f32 v62, v20, v21
    v_cvt_pk_bf16_f32 v63, v22, v23
    global_store_dwordx2 v7, v[62:63], s[10:11] offset:1536 sc1
    s_branch B_pub
B_cv1:
    ds_write_b128 v6, v[8:11] offset:0
    ds_write_b128 v6, v[12:15] offset:1024
    ds_write_b128 v6, v[16:19] offset:2048
    ds_write_b128 v6, v[20:23] offset:3072
    s_waitcnt lgkmcnt(0)
    s_barrier
    ds_read_b128 v[40:43], v5 offset:0
    ds_read_b128 v[44:47], v5 offset:1024
    ds_read_b128 v[48:51], v5 offset:2048
    ds_read_b128 v[52:55], v5 offset:3072
    s_waitcnt lgkmcnt(0)
    v_add_f32 v24, v24, v40
    v_add_f32 v25, v25, v41
    v_add_f32 v26, v26, v42
    v_add_f32 v27, v27, v43
    v_cvt_pk_bf16_f32 v56, v24, v25
    v_cvt_pk_bf16_f32 v57, v26, v27
    global_store_dwordx2 v7, v[56:57], s[10:11] offset:2048 sc1
    v_add_f32 v28, v28, v44
    v_add_f32 v29, v29, v45
    v_add_f32 v30, v30, v46
    v_add_f32 v31, v31, v47
    v_cvt_pk_bf16_f32 v58, v28, v29
    v_cvt_pk_bf16_f32 v59, v30, v31
    global_store_dwordx2 v7, v[58:59], s[10:11] offset:2560 sc1
    v_add_f32 v32, v32, v48
    v_add_f32 v33, v33, v49
    v_add_f32 v34, v34, v50
    v_add_f32 v35, v35, v51
    v_cvt_pk_bf16_f32 v60, v32, v33
    v_cvt_pk_bf16_f32 v61, v34, v35
    global_store_dwordx2 v7, v[60:61], s[10:11] offset:3072 sc1
    v_add_f32 v36, v36, v52
    v_add_f32 v37, v37, v53
    v_add_f32 v38, v38, v54
    v_add_f32 v39, v39, v55
    v_cvt_pk_bf16_f32 v62, v36, v37
    v_cvt_pk_bf16_f32 v63, v38, v39
    global_store_dwordx2 v7, v[62:63], s[10:11] offset:3584 sc1
B_pub:
    s_waitcnt vmcnt(0) lgkmcnt(0)
    s_barrier
    s_cmp_lg_u32 s69, 0
    s_cbranch_scc1 PB_end_37
    s_cmp_lg_u32 s68, 0
    s_cbranch_scc1 N_ok_39
    s_waitcnt vmcnt(0)
    v_readfirstlane_b32 s68, v255
    s_cmp_lg_u32 s68, 0
    s_cbranch_scc1 N_ok_39
    v_mov_b32 v253, 0
N_poll_38:
    global_load_dword v254, v253, s[66:67] sc1
    s_waitcnt vmcnt(0)
    v_readfirstlane_b32 s68, v254
    s_cmp_lg_u32 s68, 0
    s_cbranch_scc1 N_ok_39
    s_sleep 4
    s_branch N_poll_38
N_ok_39:
    v_mov_b32 v254, s68
    s_mov_b64 s[72:73], exec
    s_mov_b64 exec, 1
    v_mov_b32 v253, s74
    global_store_dword v253, v254, s[70:71] sc1
    s_mov_b64 exec, s[72:73]
PB_end_37:
    s_endpgm
X_exit:
    s_endpgm
.section .rodata,"a"
.p2align 6
.amdhsa_kernel recurrent_scan__ssm_conv_s4d__dense_activation_relu__prompt_kernel
  .amdhsa_next_free_vgpr 256
  .amdhsa_next_free_sgpr 96
  .amdhsa_accum_offset 256
  .amdhsa_group_segment_fixed_size 0
  .amdhsa_kernarg_size 104
  .amdhsa_user_sgpr_count 2
  .amdhsa_user_sgpr_kernarg_segment_ptr 1
  .amdhsa_system_sgpr_workgroup_id_x 1
  .amdhsa_float_denorm_mode_32 3
.end_amdhsa_kernel
```
